```python
import torch

def _softmax(x, axis=-1):
    return torch.softmax(x, dim=axis)
def _gelu(x):
    return torch.nn.functional.gelu(x, approximate="tanh")
def _silu(x):
    return torch.nn.functional.silu(x)
def _sigmoid(x):
    return torch.sigmoid(x)
def _layernorm(x, axis=-1, eps=1e-5):
    m = x.mean(dim=axis, keepdim=True)
    v = x.var(dim=axis, keepdim=True, unbiased=False)
    return (x - m) / torch.sqrt(v + eps)
def _scatter_add(tgt, idx, src, axis=0):
    return tgt.clone().index_add_(axis, idx, src)
def _segment_sum(src, seg, n):
    out = torch.zeros((n,) + src.shape[1:], dtype=src.dtype)
    return out.index_add_(0, seg, src)
def _pad(x, pw):
    flat = tuple(v for pair in reversed(pw) for v in pair)
    return torch.nn.functional.pad(x, flat)

kernel_name = 'standalone__fused_io_aware_attn__prompt'

def setup_inputs():

    _w = (lambda a: (lambda t: t.to(torch.bfloat16) if t.is_floating_point() else t)(torch.as_tensor(a)))
    B, H, S = 1, 16, 4096
    Dh = max(1, 448 // 16)
    return {
        "q": _w((lambda *s: torch.randn(*s, dtype=torch.bfloat16) * 0.8)(B, H, S, Dh)),
        "k": _w((lambda *s: torch.randn(*s, dtype=torch.bfloat16) * 0.8)(B, H, S, Dh)),
        "v": _w((lambda *s: torch.randn(*s, dtype=torch.bfloat16) * 0.05)(B, H, S, Dh)),
    }

def reference(q, k, v):
    scale = q.shape[-1] ** -0.5
    s = torch.einsum('bhqd,bhkd->bhqk', q, k) * scale
    p = _softmax(s, axis=-1)
    return torch.einsum('bhqk,bhkd->bhqd', p, v)
```

```asm
; @launch grid=(256,1,1) block=(512,1,1) lds=163840
.amdgcn_target "amdgcn-amd-amdhsa--gfx950"
.text
.globl standalone__fused_io_aware_attn__prompt_kernel
.p2align 8
.type standalone__fused_io_aware_attn__prompt_kernel,@function
standalone__fused_io_aware_attn__prompt_kernel:
    s_load_dwordx2 s[12:13], s[0:1], 8
    s_load_dwordx2 s[20:21], s[0:1], 0
    s_load_dwordx2 s[16:17], s[0:1], 16
    s_load_dwordx2 s[24:25], s[0:1], 24
    s_setprio 3
    v_lshrrev_b32 v10, 6, v0
    v_and_b32 v1, 63, v0
    s_cmp_ge_u32 s2, 256
    v_readfirstlane_b32 s28, v10
    s_cbranch_scc1 L_end
    s_and_b32 s32, s2, 7
    s_lshr_b32 s33, s2, 7
    s_lshl1_add_u32 s32, s32, s33
    s_mul_i32 s37, s32, 229376
    s_lshr_b32 s29, s28, 1
    s_and_b32 s34, s28, 1
    s_lshl2_add_u32 s35, s29, s34
    s_mul_i32 s41, s35, 896
    s_lshl_b32 s35, s35, 10
    s_add_u32 s31, s41, s37
    s_mov_b32 s14, 3670016
    s_mov_b32 s15, 0x00020000
    s_and_b32 s33, s2, 0x78
    s_lshl2_add_u32 s33, s34, s33
    s_add_u32 s33, s33, s29
    s_mul_i32 s36, s33, 1792
    v_and_b32 v10, 31, v1
    v_and_b32 v13, 32, v1
    v_mad_u32_u24 v9, v10, 56, v13
    v_lshrrev_b32 v12, 5, v1
    v_mad_i32_i24 v215, v12, -16, v9
    v_mad_i32_i24 v15, v12, -4, v215
    s_add_u32 s36, s36, s37
    s_mov_b64 s[22:23], s[14:15]
    s_mov_b64 s[18:19], s[14:15]
    v_lshlrev_b32 v8, 4, v1
    s_mul_i32 s30, s29, 3584
    s_add_u32 s30, s30, s37
    s_waitcnt lgkmcnt(0)
    buffer_load_dwordx3 v[112:114], v15, s[20:23], s36 offen offset:32
    buffer_load_dwordx4 v[116:119], v215, s[20:23], s36 offen offset:0
    buffer_load_dwordx3 v[176:178], v15, s[12:15], s30 offen offset:32
    buffer_load_dwordx4 v[180:183], v215, s[12:15], s30 offen offset:0
    s_setprio 0
    v_lshrrev_b32 v12, 2, v1
    v_mul_u32_u24 v7, 56, v12
    v_lshrrev_b32 v12, 3, v1
    v_lshrrev_b32 v4, 5, v1
    v_xor_b32 v12, v12, v4
    v_xor_b32 v12, v12, v1
    v_and_b32 v12, 3, v12
    v_lshlrev_b32 v12, 4, v12
    v_min_u32 v12, 44, v12
    v_add_u32 v7, v7, v12
    s_mov_b64 s[26:27], s[14:15]
    v_lshlrev_b32 v3, 6, v10
    v_bfe_u32 v11, v1, 1, 2
    v_bfe_u32 v12, v1, 3, 1
    v_xor_b32 v11, v11, v12
    v_xor_b32 v11, v11, v4
    v_bfe_u32 v12, v1, 2, 2
    v_lshl_add_u32 v3, v11, 4, v3
    s_lshl_b32 s32, s29, 12
    v_add_u32 v3, s32, v3
    v_xor_b32 v4, 32, v3
    v_lshrrev_b32 v10, 2, v13
    v_add_u32 v10, v10, v12
    v_and_b32 v11, 16, v1
    v_mad_u32_u24 v5, v10, 56, v11
    v_and_b32 v10, 1, v1
    v_lshl_add_u32 v5, v10, 5, v5
    v_and_b32 v10, 2, v1
    v_lshl_add_u32 v5, v10, 2, v5
    v_add_u32 v6, 224, v5
    buffer_load_dwordx3 v[184:186], v15, s[12:15], s30 offen offset:1824
    buffer_load_dwordx4 v[188:191], v215, s[12:15], s30 offen offset:1792
    s_add_u32 m0, s35, 49152
    s_mov_b32 exec_hi, 0x00ffffff
    buffer_load_dwordx4 v8, s[16:19], s31 offen lds
    s_mov_b32 exec_hi, -1
    s_add_u32 m0, s35, 49408
    s_mov_b32 exec_hi, 0x00ffffff
    buffer_load_dwordx4 v8, s[16:19], s31 offen offset:1792 lds
    s_mov_b32 exec_hi, -1
    s_add_u32 s31, s31, 14336
    v_and_b32 v10, 19, v1
    v_cmp_eq_u32 vcc, 19, v10
    v_lshlrev_b32 v11, 1, v13
    v_sub_u32 v12, 992, v11
    v_sub_u32 v11, 960, v11
    s_add_u32 s32, s32, 49152
    v_cndmask_b32 v5, v5, v12, vcc
    v_cndmask_b32 v6, v6, v11, vcc
    v_mov_b32 v212, v5
    v_mov_b32 v213, v6
    s_bitcmp1_b32 s29, 0
    s_cselect_b32 s33, 0x80008000, 0
    s_or_b32 s33, s33, 0x44804480
    v_mov_b32 v228, s33
    v_mov_b32 v229, s33
    v_mov_b32 v230, s33
    v_mov_b32 v231, s33
    v_add_u32 v5, s32, v5
    v_add_u32 v6, s32, v6
    v_mov_b32 v2, 0xdddd
    v_mov_b32 v192, 0x3f80
    v_mov_b32 v193, 0
    v_mov_b32 v194, 0x3f80
    v_mov_b32 v195, 0
    v_lshrrev_b32 v10, 3, v0
    v_lshlrev_b32 v10, 10, v10
    v_and_b32 v11, 7, v0
    v_lshl_add_u32 v10, v11, 4, v10
    v_mov_b32 v0, v15
    v_mov_b32 v179, 0xc0004000
    v_mov_b32 v187, 0xc0004000
    v_mov_b32 v219, 0xc0004000
    v_mov_b32 v235, 0xc0004000
    v_mov_b32 v171, 0x45004500
    s_cmp_ge_u32 s28, 6
    s_cbranch_scc1 L_nopad
    ds_write_b128 v10, v[192:195] offset:50048
L_nopad:
    s_lshl_b32 s33, s28, 12
    s_add_u32 s32, s33, 98304
    v_add_u32 v14, s32, v8
    v_add_u32 v214, s32, v9
    s_add_u32 s33, s33, 8192
    s_and_b32 s33, s33, 32767
    s_add_u32 s32, s33, 98304
    v_add_u32 v208, s32, v8
    s_add_u32 s33, s33, 8192
    s_and_b32 s33, s33, 32767
    s_add_u32 s32, s33, 98304
    v_add_u32 v209, s32, v8
    s_add_u32 s33, s33, 8192
    s_and_b32 s33, s33, 32767
    s_add_u32 s32, s33, 98304
    v_add_u32 v210, s32, v8
    v_subrev_u32 v211, 81920, v210
    v_subrev_u32 v15, 81920, v14
    s_add_u32 s38, s37, 229376
    s_mov_b32 s42, -1
    s_mov_b32 s39, 0x44800000
    s_mov_b32 s40, 0x37000000
    v_mov_b32 v10, 0x3e8b97f6
    s_waitcnt vmcnt(6) lgkmcnt(0)
    v_lshlrev_b32 v128, 16, v112
    v_and_b32 v129, 0xffff0000, v112
    v_lshlrev_b32 v130, 16, v113
    v_and_b32 v131, 0xffff0000, v113
    v_lshlrev_b32 v132, 16, v114
    v_and_b32 v133, 0xffff0000, v114
    v_pk_mul_f32 v[128:129], v[128:129], v[10:11] op_sel_hi:[1,0]
    v_pk_mul_f32 v[130:131], v[130:131], v[10:11] op_sel_hi:[1,0]
    v_pk_mul_f32 v[132:133], v[132:133], v[10:11] op_sel_hi:[1,0]
    v_cvt_pk_bf16_f32 v168, v128, v129
    v_cvt_pk_bf16_f32 v169, v130, v131
    v_cvt_pk_bf16_f32 v170, v132, v133
    ds_write_b128 v14, v[168:171]
    v_lshlrev_b32 v136, 16, v116
    v_and_b32 v137, 0xffff0000, v116
    v_lshlrev_b32 v138, 16, v117
    v_and_b32 v139, 0xffff0000, v117
    v_lshlrev_b32 v140, 16, v118
    v_and_b32 v141, 0xffff0000, v118
    v_lshlrev_b32 v142, 16, v119
    v_and_b32 v143, 0xffff0000, v119
    v_pk_mul_f32 v[136:137], v[136:137], v[10:11] op_sel_hi:[1,0]
    v_pk_mul_f32 v[138:139], v[138:139], v[10:11] op_sel_hi:[1,0]
    v_pk_mul_f32 v[140:141], v[140:141], v[10:11] op_sel_hi:[1,0]
    v_pk_mul_f32 v[142:143], v[142:143], v[10:11] op_sel_hi:[1,0]
    v_cvt_pk_bf16_f32 v172, v136, v137
    v_cvt_pk_bf16_f32 v173, v138, v139
    v_cvt_pk_bf16_f32 v174, v140, v141
    v_cvt_pk_bf16_f32 v175, v142, v143
    ds_write_b128 v14, v[172:175] offset:1024
    s_waitcnt vmcnt(4)
    s_nop 0
    v_mfma_f32_32x32x16_bf16 v[80:95], v[180:183], v[172:175], 4.0
    v_mfma_f32_32x32x16_bf16 v[80:95], v[176:179], v[168:171], v[80:95]
    s_add_u32 m0, s35, 16384
    s_nop 0
    buffer_load_dwordx4 v7, s[12:15], s31 offen lds
    s_add_u32 m0, s35, 65536
    s_mov_b32 exec_hi, 0x00ffffff
    buffer_load_dwordx4 v8, s[16:19], s31 offen lds
    s_mov_b32 exec_hi, -1
    s_add_u32 m0, s35, 16640
    s_nop 0
    buffer_load_dwordx4 v7, s[12:15], s31 offen offset:1792 lds
    s_waitcnt vmcnt(5)
    v_mfma_f32_32x32x16_bf16 v[96:111], v[188:191], v[172:175], 4.0
    v_exp_f32 v80, v80
    v_exp_f32 v81, v81
    v_exp_f32 v82, v82
    v_exp_f32 v83, v83
    v_mfma_f32_32x32x16_bf16 v[96:111], v[184:187], v[168:171], v[96:111]
    v_exp_f32 v84, v84
    v_exp_f32 v85, v85
    v_exp_f32 v86, v86
    v_exp_f32 v87, v87
    s_add_u32 m0, s35, 65792
    s_mov_b32 exec_hi, 0x00ffffff
    buffer_load_dwordx4 v8, s[16:19], s31 offen offset:1792 lds
    s_mov_b32 exec_hi, -1
    s_add_u32 s31, s31, 14336
    v_exp_f32 v88, v88
    v_exp_f32 v89, v89
    v_exp_f32 v90, v90
    v_exp_f32 v91, v91
    v_exp_f32 v92, v92
    v_exp_f32 v93, v93
    s_waitcnt vmcnt(4) lgkmcnt(0)
    s_barrier
    ds_read_b128 v[144:147], v208
    ds_read_b128 v[148:151], v208 offset:1024
    v_exp_f32 v94, v94
    ds_read_b64_tr_b16 v[192:193], v5 offset:0
    ds_read_b64_tr_b16 v[194:195], v6 offset:0
    ds_read_b64_tr_b16 v[196:197], v5 offset:1024
    ds_read_b64_tr_b16 v[198:199], v6 offset:1024
    v_exp_f32_e64 v95, v95
    s_setprio 2
    s_waitcnt lgkmcnt(4)
    v_mfma_f32_32x32x16_bf16 v[112:127], v[180:183], v[148:151], 4.0
    v_exp_f32 v96, v96
    ds_read_b64_tr_b16 v[224:225], v212 offset:49152
    ds_read_b64_tr_b16 v[226:227], v213 offset:49152
    v_exp_f32 v97, v97
    v_exp_f32 v98, v98
    s_waitcnt lgkmcnt(1)
    v_and_b32 v224, 0x7fff7fff, v224
    v_and_b32 v225, 0x7fff7fff, v225
    s_waitcnt lgkmcnt(0)
    v_and_b32 v226, 0x7fff7fff, v226
    v_and_b32 v227, 0x7fff7fff, v227
    v_exp_f32 v99, v99
    v_mfma_f32_32x32x16_bf16 v[112:127], v[176:179], v[144:147], v[112:127]
    v_exp_f32 v100, v100
    ds_read_b128 v[152:155], v209
    ds_read_b128 v[156:159], v209 offset:1024
    v_exp_f32 v101, v101
    v_mfma_f32_32x32x16_bf16 v[64:79], v[224:227], v[228:231], 0
    v_exp_f32 v102, v102
    ds_read_b64_tr_b16 v[200:201], v5 offset:2048
    ds_read_b64_tr_b16 v[202:203], v6 offset:2048
    ds_read_b64_tr_b16 v[204:205], v5 offset:3072
    ds_read_b64_tr_b16 v[206:207], v6 offset:3072
    v_exp_f32 v103, v103
    v_smfmac_f32_32x32x32_bf16 v[64:79], v[192:195], v[80:87], v2
    v_exp_f32 v104, v104
    v_exp_f32 v105, v105
    s_add_u32 m0, s35, 32768
    s_nop 0
    buffer_load_dwordx4 v7, s[12:15], s31 offen lds
    v_exp_f32 v106, v106
    v_exp_f32_e64 v107, v107
    v_smfmac_f32_32x32x32_bf16 v[64:79], v[196:199], v[88:95], v2
    v_exp_f32 v108, v108
    v_exp_f32 v109, v109
    s_cmp_ge_u32 s2, 16
    s_cbranch_scc1 L_nopf
    s_getpc_b64 s[4:5]
L_pfpc:
    s_lshl_b32 s6, s28, 12
    v_lshl_add_u32 v12, v1, 6, s6
    v_min_u32 v12, L_end-L_pfpc, v12
    v_mov_b32 v13, s5
    v_add_co_u32 v12, vcc, s4, v12
    s_nop 1
    v_addc_co_u32 v13, vcc, 0, v13, vcc
    global_load_dword v13, v[12:13], off
L_nopf:
    v_exp_f32 v110, v110
    v_exp_f32 v111, v111
    ds_read_b128 v[160:163], v210
    ds_read_b128 v[164:167], v210 offset:1024
    s_waitcnt lgkmcnt(2)
    v_mfma_f32_32x32x16_bf16 v[128:143], v[180:183], v[156:159], 4.0
    v_exp_f32 v112, v112
    v_exp_f32 v113, v113
    s_add_u32 m0, s35, 81920
    s_mov_b32 exec_hi, 0x00ffffff
    buffer_load_dwordx4 v8, s[16:19], s31 offen lds
    s_mov_b32 exec_hi, -1
    v_mfma_f32_32x32x16_bf16 v[16:31], v[224:227], v[228:231], 0
    v_exp_f32 v114, v114
    v_exp_f32 v115, v115
    v_mfma_f32_32x32x16_bf16 v[128:143], v[176:179], v[152:155], v[128:143]
    v_exp_f32 v116, v116
    v_exp_f32 v117, v117
    v_exp_f32 v118, v118
    v_exp_f32 v119, v119
    v_smfmac_f32_32x32x32_bf16 v[64:79], v[200:203], v[96:103], v2
    v_exp_f32_e64 v120, v120
    v_mfma_f32_32x32x16_bf16 v[32:47], v[224:227], v[228:231], 0
    v_exp_f32 v121, v121
    v_exp_f32 v122, v122
    v_exp_f32_e64 v123, v123
    v_smfmac_f32_32x32x32_bf16 v[64:79], v[204:207], v[104:111], v2
    v_exp_f32 v124, v124
    v_exp_f32 v125, v125
    v_exp_f32 v126, v126
    v_exp_f32_e64 v127, v127
    s_waitcnt lgkmcnt(0)
    v_mfma_f32_32x32x16_bf16 v[80:95], v[180:183], v[164:167], 4.0
    v_exp_f32 v128, v128
    v_exp_f32 v129, v129
    v_exp_f32 v130, v130
    v_exp_f32 v131, v131
    v_mfma_f32_32x32x16_bf16 v[80:95], v[176:179], v[160:163], v[80:95]
    v_exp_f32 v132, v132
    v_exp_f32 v133, v133
    v_exp_f32 v134, v134
    v_exp_f32 v135, v135
    v_smfmac_f32_32x32x32_bf16 v[16:31], v[192:195], v[112:119], v2
    v_exp_f32 v136, v136
    v_exp_f32 v137, v137
    s_add_u32 m0, s35, 33024
    s_nop 0
    buffer_load_dwordx4 v7, s[12:15], s31 offen offset:1792 lds
    v_exp_f32 v138, v138
    v_exp_f32_e64 v139, v139
    v_smfmac_f32_32x32x32_bf16 v[16:31], v[196:199], v[120:127], v2
    v_exp_f32 v140, v140
    v_exp_f32 v141, v141
    v_exp_f32 v142, v142
    v_exp_f32 v143, v143
    v_mfma_f32_32x32x16_bf16 v[96:111], v[188:191], v[148:151], 4.0
    v_exp_f32 v80, v80
    v_exp_f32 v81, v81
    s_add_u32 m0, s35, 82176
    s_mov_b32 exec_hi, 0x00ffffff
    buffer_load_dwordx4 v8, s[16:19], s31 offen offset:1792 lds
    s_mov_b32 exec_hi, -1
    s_add_u32 s31, s31, 14336
    v_exp_f32 v82, v82
    v_exp_f32_e64 v83, v83
    v_mfma_f32_32x32x16_bf16 v[96:111], v[184:187], v[144:147], v[96:111]
    v_exp_f32 v84, v84
    v_exp_f32 v85, v85
    v_exp_f32 v86, v86
    v_exp_f32 v87, v87
    v_smfmac_f32_32x32x32_bf16 v[32:47], v[192:195], v[128:135], v2
    v_exp_f32 v88, v88
    v_exp_f32 v89, v89
    v_mfma_f32_32x32x16_bf16 v[48:63], v[224:227], v[228:231], 0
    v_exp_f32 v90, v90
    v_exp_f32_e64 v91, v91
    s_setprio 1
    v_smfmac_f32_32x32x32_bf16 v[32:47], v[196:199], v[136:143], v2
    v_exp_f32 v92, v92
    v_exp_f32 v93, v93
    v_exp_f32 v94, v94
    v_exp_f32 v95, v95
    v_mfma_f32_32x32x16_bf16 v[112:127], v[188:191], v[156:159], 4.0
    v_exp_f32 v96, v96
    v_exp_f32 v97, v97
    v_exp_f32 v98, v98
    v_exp_f32 v99, v99
    v_mfma_f32_32x32x16_bf16 v[112:127], v[184:187], v[152:155], v[112:127]
    v_exp_f32 v100, v100
    v_exp_f32 v101, v101
    v_exp_f32 v102, v102
    v_exp_f32 v103, v103
    v_smfmac_f32_32x32x32_bf16 v[48:63], v[192:195], v[80:87], v2
    v_exp_f32 v104, v104
    v_exp_f32 v105, v105
    v_exp_f32 v106, v106
    v_exp_f32_e64 v107, v107
    s_setprio 0
    v_smfmac_f32_32x32x32_bf16 v[48:63], v[196:199], v[88:95], v2
    v_exp_f32 v108, v108
    v_exp_f32 v109, v109
    v_exp_f32 v110, v110
    s_waitcnt vmcnt(4)
    s_barrier
    v_exp_f32 v111, v111
    v_mfma_f32_32x32x16_bf16 v[128:143], v[188:191], v[164:167], 4.0
    v_exp_f32 v112, v112
    v_exp_f32 v113, v113
    ds_read_b64_tr_b16 v[192:193], v5 offset:16384
    ds_read_b64_tr_b16 v[194:195], v6 offset:16384
    s_setprio 3
    v_exp_f32 v114, v114
    v_exp_f32_e64 v115, v115
    v_mfma_f32_32x32x16_bf16 v[128:143], v[184:187], v[160:163], v[128:143]
    v_exp_f32 v116, v116
    v_exp_f32 v117, v117
    ds_read_b96 v[176:178], v4 offset:16384
    ds_read_b128 v[180:183], v3 offset:16384
    s_add_u32 m0, s35, 0
    s_nop 0
    buffer_load_dwordx4 v7, s[12:15], s31 offen lds
    v_exp_f32 v118, v118
    v_exp_f32 v119, v119
    v_smfmac_f32_32x32x32_bf16 v[16:31], v[200:203], v[96:103], v2
    v_exp_f32 v120, v120
    v_exp_f32 v121, v121
    ds_read_b64_tr_b16 v[196:197], v5 offset:17408
    ds_read_b64_tr_b16 v[198:199], v6 offset:17408
    v_exp_f32 v122, v122
    v_exp_f32 v123, v123
    v_smfmac_f32_32x32x32_bf16 v[16:31], v[204:207], v[104:111], v2
    v_exp_f32 v124, v124
    v_exp_f32 v125, v125
    v_exp_f32 v126, v126
    v_exp_f32_e64 v127, v127
    s_waitcnt lgkmcnt(2)
    v_mfma_f32_32x32x16_bf16 v[80:95], v[180:183], v[148:151], 4.0
    v_exp_f32 v128, v128
    v_exp_f32 v129, v129
    s_add_u32 m0, s35, 49152
    s_mov_b32 exec_hi, 0x00ffffff
    buffer_load_dwordx4 v8, s[16:19], s31 offen lds
    s_mov_b32 exec_hi, -1
    v_exp_f32 v130, v130
    v_exp_f32_e64 v131, v131
    v_mfma_f32_32x32x16_bf16 v[80:95], v[176:179], v[144:147], v[80:95]
    v_exp_f32 v132, v132
    v_exp_f32 v133, v133
    v_exp_f32 v134, v134
    v_exp_f32 v135, v135
    v_smfmac_f32_32x32x32_bf16 v[32:47], v[200:203], v[112:119], v2
    v_exp_f32 v136, v136
    v_exp_f32 v137, v137
    s_add_u32 m0, s35, 256
    s_nop 0
    buffer_load_dwordx4 v7, s[12:15], s31 offen offset:1792 lds
    v_exp_f32 v138, v138
    v_exp_f32_e64 v139, v139
    v_smfmac_f32_32x32x32_bf16 v[32:47], v[204:207], v[120:127], v2
    v_exp_f32 v140, v140
    v_exp_f32 v141, v141
    v_exp_f32 v142, v142
    v_exp_f32 v143, v143
    v_mfma_f32_32x32x16_bf16 v[96:111], v[180:183], v[156:159], 4.0
    v_exp_f32 v80, v80
    v_exp_f32 v81, v81
    v_exp_f32 v82, v82
    v_exp_f32 v83, v83
    v_mfma_f32_32x32x16_bf16 v[96:111], v[176:179], v[152:155], v[96:111]
    v_exp_f32 v84, v84
    v_exp_f32 v85, v85
    v_exp_f32 v86, v86
    v_exp_f32 v87, v87
    v_smfmac_f32_32x32x32_bf16 v[48:63], v[200:203], v[128:135], v2
    v_exp_f32 v88, v88
    v_exp_f32 v89, v89
    v_exp_f32 v90, v90
    v_exp_f32 v91, v91
    v_smfmac_f32_32x32x32_bf16 v[48:63], v[204:207], v[136:143], v2
    v_exp_f32 v92, v92
    v_exp_f32 v93, v93
    v_exp_f32 v94, v94
    v_exp_f32 v95, v95
    v_mfma_f32_32x32x16_bf16 v[112:127], v[180:183], v[164:167], 4.0
    v_exp_f32 v96, v96
    ds_read_b64_tr_b16 v[202:203], v6 offset:18432
    v_exp_f32 v97, v97
    ds_read_b96 v[184:186], v4 offset:18432
    ds_read_b64_tr_b16 v[200:201], v5 offset:18432
    v_exp_f32 v98, v98
    v_exp_f32 v99, v99
    ds_read_b128 v[188:191], v3 offset:18432
    v_mfma_f32_32x32x16_bf16 v[112:127], v[176:179], v[160:163], v[112:127]
    v_exp_f32 v100, v100
    v_exp_f32 v101, v101
    v_exp_f32 v102, v102
    v_exp_f32 v103, v103
    v_smfmac_f32_32x32x32_bf16 v[16:31], v[192:195], v[80:87], v2
    v_exp_f32 v104, v104
    v_exp_f32 v105, v105
    ds_read_b64_tr_b16 v[204:205], v5 offset:19456
    ds_read_b64_tr_b16 v[206:207], v6 offset:19456
    s_setprio 2
    v_exp_f32 v106, v106
    v_exp_f32 v107, v107
    s_waitcnt lgkmcnt(2)
    v_smfmac_f32_32x32x32_bf16 v[16:31], v[196:199], v[88:95], v2
    v_exp_f32 v108, v108
    v_exp_f32 v109, v109
    v_exp_f32 v110, v110
    v_exp_f32 v111, v111
    v_mfma_f32_32x32x16_bf16 v[128:143], v[180:183], v[172:175], 4.0
    v_exp_f32 v112, v112
    v_exp_f32 v113, v113
    v_exp_f32 v114, v114
    v_exp_f32 v115, v115
    v_mfma_f32_32x32x16_bf16 v[128:143], v[176:179], v[168:171], v[128:143]
    v_exp_f32 v116, v116
    v_exp_f32 v117, v117
    v_exp_f32 v118, v118
    v_exp_f32 v119, v119
    s_add_u32 m0, s35, 49408
    s_mov_b32 exec_hi, 0x00ffffff
    buffer_load_dwordx4 v8, s[16:19], s31 offen offset:1792 lds
    s_mov_b32 exec_hi, -1
    s_add_u32 s31, s31, 14336
    v_smfmac_f32_32x32x32_bf16 v[32:47], v[192:195], v[96:103], v2
    v_exp_f32 v120, v120
    v_exp_f32 v121, v121
    v_exp_f32 v122, v122
    v_exp_f32_e64 v123, v123
    v_smfmac_f32_32x32x32_bf16 v[32:47], v[196:199], v[104:111], v2
    v_exp_f32 v124, v124
    v_exp_f32 v125, v125
    v_exp_f32 v126, v126
    v_exp_f32_e64 v127, v127
    s_setprio 1
    v_mfma_f32_32x32x16_bf16 v[80:95], v[188:191], v[148:151], 4.0
    v_exp_f32 v128, v128
    v_exp_f32 v129, v129
    v_exp_f32 v130, v130
    v_exp_f32 v131, v131
    v_mfma_f32_32x32x16_bf16 v[80:95], v[184:187], v[144:147], v[80:95]
    v_exp_f32 v132, v132
    v_exp_f32 v133, v133
    v_exp_f32 v134, v134
    v_exp_f32 v135, v135
    v_smfmac_f32_32x32x32_bf16 v[48:63], v[192:195], v[112:119], v2
    v_exp_f32 v136, v136
    v_exp_f32 v137, v137
    v_exp_f32 v138, v138
    v_exp_f32 v139, v139
    v_smfmac_f32_32x32x32_bf16 v[48:63], v[196:199], v[120:127], v2
    v_exp_f32 v140, v140
    v_exp_f32 v141, v141
    s_setprio 0
    v_exp_f32 v142, v142
    v_exp_f32_e64 v143, v143
    v_mfma_f32_32x32x16_bf16 v[96:111], v[188:191], v[156:159], 4.0
    v_exp_f32 v80, v80
    v_exp_f32 v81, v81
    v_exp_f32 v82, v82
    v_exp_f32 v83, v83
    v_mfma_f32_32x32x16_bf16 v[96:111], v[184:187], v[152:155], v[96:111]
    v_exp_f32 v84, v84
    s_waitcnt vmcnt(4) lgkmcnt(0)
    s_barrier
    v_exp_f32 v85, v85
    s_setprio 3
    v_exp_f32 v86, v86
    v_exp_f32_e64 v87, v87
    v_smfmac_f32_32x32x32_bf16 v[64:79], v[192:195], v[128:135], v2
    v_exp_f32 v88, v88
    v_exp_f32 v89, v89
    ds_read_b128 v[180:183], v3 offset:32768
    s_add_u32 m0, s35, 16384
    s_nop 0
    buffer_load_dwordx4 v7, s[12:15], s31 offen lds
    v_exp_f32 v90, v90
    v_exp_f32_e64 v91, v91
    v_smfmac_f32_32x32x32_bf16 v[64:79], v[196:199], v[136:143], v2
    v_exp_f32 v92, v92
    v_exp_f32 v93, v93
    v_exp_f32 v94, v94
    v_exp_f32 v95, v95
    v_mfma_f32_32x32x16_bf16 v[112:127], v[188:191], v[164:167], 4.0
    v_exp_f32 v96, v96
    v_exp_f32 v97, v97
    ds_read_b96 v[176:178], v4 offset:32768
    ds_read_b64_tr_b16 v[192:193], v5 offset:32768
    v_exp_f32 v98, v98
    v_exp_f32 v99, v99
    v_mfma_f32_32x32x16_bf16 v[112:127], v[184:187], v[160:163], v[112:127]
    v_exp_f32 v100, v100
    v_exp_f32 v101, v101
    v_exp_f32 v102, v102
    v_exp_f32 v103, v103
    v_smfmac_f32_32x32x32_bf16 v[16:31], v[200:203], v[80:87], v2
    v_exp_f32 v104, v104
    v_exp_f32 v105, v105
    v_exp_f32 v106, v106
    v_exp_f32 v107, v107
    ds_read_b64_tr_b16 v[194:195], v6 offset:32768
    ds_read_b64_tr_b16 v[196:197], v5 offset:33792
    ds_read_b64_tr_b16 v[198:199], v6 offset:33792
    v_smfmac_f32_32x32x32_bf16 v[16:31], v[204:207], v[88:95], v2
    v_exp_f32 v108, v108
    v_exp_f32 v109, v109
    v_exp_f32 v110, v110
    v_exp_f32 v111, v111
    v_mfma_f32_32x32x16_bf16 v[128:143], v[188:191], v[172:175], 4.0
    v_exp_f32 v112, v112
    v_exp_f32 v113, v113
    v_exp_f32 v114, v114
    v_exp_f32 v115, v115
    v_mfma_f32_32x32x16_bf16 v[128:143], v[184:187], v[168:171], v[128:143]
    v_exp_f32 v116, v116
    v_exp_f32 v117, v117
    v_exp_f32 v118, v118
    v_exp_f32 v119, v119
    v_smfmac_f32_32x32x32_bf16 v[32:47], v[200:203], v[96:103], v2
    v_exp_f32 v120, v120
    v_exp_f32 v121, v121
    s_add_u32 m0, s35, 65536
    s_mov_b32 exec_hi, 0x00ffffff
    buffer_load_dwordx4 v8, s[16:19], s31 offen lds
    s_mov_b32 exec_hi, -1
    v_exp_f32 v122, v122
    v_exp_f32_e64 v123, v123
    v_smfmac_f32_32x32x32_bf16 v[32:47], v[204:207], v[104:111], v2
    v_exp_f32 v124, v124
    v_exp_f32 v125, v125
    v_exp_f32 v126, v126
    v_exp_f32_e64 v127, v127
    s_waitcnt lgkmcnt(0)
    v_mfma_f32_32x32x16_bf16 v[80:95], v[180:183], v[148:151], 4.0
    v_exp_f32 v128, v128
    v_exp_f32 v129, v129
    v_exp_f32 v130, v130
    v_exp_f32 v131, v131
    v_mfma_f32_32x32x16_bf16 v[80:95], v[176:179], v[144:147], v[80:95]
    v_exp_f32 v132, v132
    v_exp_f32 v133, v133
    s_add_u32 m0, s35, 16640
    s_nop 0
    buffer_load_dwordx4 v7, s[12:15], s31 offen offset:1792 lds
    v_exp_f32 v134, v134
    v_exp_f32_e64 v135, v135
    v_smfmac_f32_32x32x32_bf16 v[48:63], v[200:203], v[112:119], v2
    v_exp_f32 v136, v136
    v_exp_f32 v137, v137
    v_exp_f32 v138, v138
    v_exp_f32 v139, v139
    v_smfmac_f32_32x32x32_bf16 v[48:63], v[204:207], v[120:127], v2
    v_exp_f32 v140, v140
    v_exp_f32 v141, v141
    v_exp_f32 v142, v142
    v_exp_f32 v143, v143
    v_mfma_f32_32x32x16_bf16 v[96:111], v[180:183], v[156:159], 4.0
    v_exp_f32 v80, v80
    v_exp_f32 v81, v81
    v_exp_f32 v82, v82
    v_exp_f32 v83, v83
    v_mfma_f32_32x32x16_bf16 v[96:111], v[176:179], v[152:155], v[96:111]
    v_exp_f32 v84, v84
    v_exp_f32 v85, v85
    v_exp_f32 v86, v86
    v_exp_f32 v87, v87
    v_smfmac_f32_32x32x32_bf16 v[64:79], v[200:203], v[128:135], v2
    v_exp_f32 v88, v88
    v_exp_f32 v89, v89
    v_exp_f32 v90, v90
    v_exp_f32 v91, v91
    v_smfmac_f32_32x32x32_bf16 v[64:79], v[204:207], v[136:143], v2
    v_exp_f32 v92, v92
    v_exp_f32 v93, v93
    v_exp_f32 v94, v94
    v_exp_f32 v95, v95
    ds_read_b96 v[184:186], v4 offset:34816
    ds_read_b128 v[188:191], v3 offset:34816
    ds_read_b64_tr_b16 v[200:201], v5 offset:34816
    v_mfma_f32_32x32x16_bf16 v[112:127], v[180:183], v[164:167], 4.0
    v_exp_f32 v96, v96
    v_exp_f32 v97, v97
    v_exp_f32 v98, v98
    v_exp_f32 v99, v99
    v_mfma_f32_32x32x16_bf16 v[112:127], v[176:179], v[160:163], v[112:127]
    v_exp_f32 v100, v100
    v_exp_f32 v101, v101
    v_exp_f32 v102, v102
    v_exp_f32 v103, v103
    v_smfmac_f32_32x32x32_bf16 v[16:31], v[192:195], v[80:87], v2
    v_exp_f32 v104, v104
    v_exp_f32 v105, v105
    ds_read_b64_tr_b16 v[202:203], v6 offset:34816
    ds_read_b64_tr_b16 v[206:207], v6 offset:35840
    s_setprio 2
    v_exp_f32 v106, v106
    v_exp_f32_e64 v107, v107
    v_smfmac_f32_32x32x32_bf16 v[16:31], v[196:199], v[88:95], v2
    v_exp_f32 v108, v108
    v_exp_f32 v109, v109
    v_exp_f32 v110, v110
    v_exp_f32 v111, v111
    v_mfma_f32_32x32x16_bf16 v[128:143], v[180:183], v[172:175], 4.0
    v_exp_f32 v112, v112
    v_exp_f32 v113, v113
    v_exp_f32 v114, v114
    v_exp_f32 v115, v115
    v_mfma_f32_32x32x16_bf16 v[128:143], v[176:179], v[168:171], v[128:143]
    v_exp_f32 v116, v116
    v_exp_f32 v117, v117
    v_exp_f32 v118, v118
    v_exp_f32 v119, v119
    v_smfmac_f32_32x32x32_bf16 v[32:47], v[192:195], v[96:103], v2
    v_exp_f32 v120, v120
    v_exp_f32 v121, v121
    v_exp_f32 v122, v122
    v_exp_f32 v123, v123
    v_smfmac_f32_32x32x32_bf16 v[32:47], v[196:199], v[104:111], v2
    v_exp_f32 v124, v124
    v_exp_f32 v125, v125
    ds_read_b64_tr_b16 v[204:205], v5 offset:35840
    v_exp_f32 v126, v126
    v_exp_f32 v127, v127
    s_setprio 1
    s_waitcnt lgkmcnt(1)
    v_mfma_f32_32x32x16_bf16 v[80:95], v[188:191], v[148:151], 4.0
    v_exp_f32 v128, v128
    v_exp_f32 v129, v129
    v_exp_f32 v130, v130
    v_exp_f32 v131, v131
    v_mfma_f32_32x32x16_bf16 v[80:95], v[184:187], v[144:147], v[80:95]
    v_exp_f32 v132, v132
    v_exp_f32 v133, v133
    v_exp_f32 v134, v134
    s_add_u32 m0, s35, 65792
    s_mov_b32 exec_hi, 0x00ffffff
    buffer_load_dwordx4 v8, s[16:19], s31 offen offset:1792 lds
    s_mov_b32 exec_hi, -1
    s_add_u32 s31, s31, 14336
    v_exp_f32_e64 v135, v135
    v_smfmac_f32_32x32x32_bf16 v[48:63], v[192:195], v[112:119], v2
    v_exp_f32 v136, v136
    v_exp_f32 v137, v137
    v_exp_f32 v138, v138
    v_exp_f32 v139, v139
    v_smfmac_f32_32x32x32_bf16 v[48:63], v[196:199], v[120:127], v2
    v_exp_f32 v140, v140
    v_exp_f32 v141, v141
    s_setprio 0
    v_exp_f32 v142, v142
    v_exp_f32_e64 v143, v143
    v_mfma_f32_32x32x16_bf16 v[96:111], v[188:191], v[156:159], 4.0
    v_exp_f32 v80, v80
    v_exp_f32 v81, v81
    v_exp_f32 v82, v82
    v_exp_f32 v83, v83
    v_mfma_f32_32x32x16_bf16 v[96:111], v[184:187], v[152:155], v[96:111]
    v_exp_f32 v84, v84
    s_waitcnt vmcnt(4) lgkmcnt(0)
    s_barrier
    v_exp_f32 v85, v85
    s_setprio 3
    v_exp_f32 v86, v86
    v_exp_f32_e64 v87, v87
    v_smfmac_f32_32x32x32_bf16 v[64:79], v[192:195], v[128:135], v2
    v_exp_f32 v88, v88
    v_exp_f32 v89, v89
    ds_read_b128 v[180:183], v3 offset:0
    s_add_u32 m0, s35, 32768
    s_nop 0
    buffer_load_dwordx4 v7, s[12:15], s31 offen lds
    v_exp_f32 v90, v90
    v_exp_f32_e64 v91, v91
    v_smfmac_f32_32x32x32_bf16 v[64:79], v[196:199], v[136:143], v2
    v_exp_f32 v92, v92
    v_exp_f32 v93, v93
    v_exp_f32 v94, v94
    v_exp_f32 v95, v95
    v_mfma_f32_32x32x16_bf16 v[112:127], v[188:191], v[164:167], 4.0
    v_exp_f32 v96, v96
    v_exp_f32 v97, v97
    ds_read_b96 v[176:178], v4 offset:0
    ds_read_b64_tr_b16 v[192:193], v5 offset:0
    v_exp_f32 v98, v98
    v_exp_f32 v99, v99
    v_mfma_f32_32x32x16_bf16 v[112:127], v[184:187], v[160:163], v[112:127]
    v_exp_f32 v100, v100
    v_exp_f32 v101, v101
    v_exp_f32 v102, v102
    v_exp_f32 v103, v103
    v_smfmac_f32_32x32x32_bf16 v[16:31], v[200:203], v[80:87], v2
    v_exp_f32 v104, v104
    v_exp_f32 v105, v105
    v_exp_f32 v106, v106
    v_exp_f32 v107, v107
    ds_read_b64_tr_b16 v[194:195], v6 offset:0
    ds_read_b64_tr_b16 v[196:197], v5 offset:1024
    ds_read_b64_tr_b16 v[198:199], v6 offset:1024
    v_smfmac_f32_32x32x32_bf16 v[16:31], v[204:207], v[88:95], v2
    v_exp_f32 v108, v108
    v_exp_f32 v109, v109
    v_exp_f32 v110, v110
    v_exp_f32 v111, v111
    v_mfma_f32_32x32x16_bf16 v[128:143], v[188:191], v[172:175], 4.0
    v_exp_f32 v112, v112
    v_exp_f32 v113, v113
    v_exp_f32 v114, v114
    v_exp_f32 v115, v115
    v_mfma_f32_32x32x16_bf16 v[128:143], v[184:187], v[168:171], v[128:143]
    v_exp_f32 v116, v116
    v_exp_f32 v117, v117
    v_exp_f32 v118, v118
    v_exp_f32 v119, v119
    v_smfmac_f32_32x32x32_bf16 v[32:47], v[200:203], v[96:103], v2
    v_exp_f32 v120, v120
    v_exp_f32 v121, v121
    s_add_u32 m0, s35, 81920
    s_mov_b32 exec_hi, 0x00ffffff
    buffer_load_dwordx4 v8, s[16:19], s31 offen lds
    s_mov_b32 exec_hi, -1
    v_exp_f32 v122, v122
    v_exp_f32_e64 v123, v123
    v_smfmac_f32_32x32x32_bf16 v[32:47], v[204:207], v[104:111], v2
    v_exp_f32 v124, v124
    v_exp_f32 v125, v125
    v_exp_f32 v126, v126
    v_exp_f32_e64 v127, v127
    s_waitcnt lgkmcnt(0)
    v_mfma_f32_32x32x16_bf16 v[80:95], v[180:183], v[148:151], 4.0
    v_exp_f32 v128, v128
    v_exp_f32 v129, v129
    v_exp_f32 v130, v130
    v_exp_f32 v131, v131
    v_mfma_f32_32x32x16_bf16 v[80:95], v[176:179], v[144:147], v[80:95]
    v_exp_f32 v132, v132
    v_exp_f32 v133, v133
    s_add_u32 m0, s35, 33024
    s_nop 0
    buffer_load_dwordx4 v7, s[12:15], s31 offen offset:1792 lds
    v_exp_f32 v134, v134
    v_exp_f32_e64 v135, v135
    v_smfmac_f32_32x32x32_bf16 v[48:63], v[200:203], v[112:119], v2
    v_exp_f32 v136, v136
    v_exp_f32 v137, v137
    v_exp_f32 v138, v138
    v_exp_f32 v139, v139
    v_smfmac_f32_32x32x32_bf16 v[48:63], v[204:207], v[120:127], v2
    v_exp_f32 v140, v140
    v_exp_f32 v141, v141
    v_exp_f32 v142, v142
    v_exp_f32 v143, v143
    v_mfma_f32_32x32x16_bf16 v[96:111], v[180:183], v[156:159], 4.0
    v_exp_f32 v80, v80
    v_exp_f32 v81, v81
    v_exp_f32 v82, v82
    v_exp_f32 v83, v83
    v_mfma_f32_32x32x16_bf16 v[96:111], v[176:179], v[152:155], v[96:111]
    v_exp_f32 v84, v84
    v_exp_f32 v85, v85
    v_exp_f32 v86, v86
    v_exp_f32 v87, v87
    v_smfmac_f32_32x32x32_bf16 v[64:79], v[200:203], v[128:135], v2
    v_exp_f32 v88, v88
    v_exp_f32 v89, v89
    v_exp_f32 v90, v90
    v_exp_f32 v91, v91
    v_smfmac_f32_32x32x32_bf16 v[64:79], v[204:207], v[136:143], v2
    v_exp_f32 v92, v92
    v_exp_f32 v93, v93
    v_exp_f32 v94, v94
    v_exp_f32 v95, v95
    ds_read_b96 v[184:186], v4 offset:2048
    ds_read_b128 v[188:191], v3 offset:2048
    ds_read_b64_tr_b16 v[200:201], v5 offset:2048
    v_mfma_f32_32x32x16_bf16 v[112:127], v[180:183], v[164:167], 4.0
    v_exp_f32 v96, v96
    v_exp_f32 v97, v97
    v_exp_f32 v98, v98
    v_exp_f32 v99, v99
    v_mfma_f32_32x32x16_bf16 v[112:127], v[176:179], v[160:163], v[112:127]
    v_exp_f32 v100, v100
    v_exp_f32 v101, v101
    v_exp_f32 v102, v102
    v_exp_f32 v103, v103
    v_smfmac_f32_32x32x32_bf16 v[16:31], v[192:195], v[80:87], v2
    v_exp_f32 v104, v104
    v_exp_f32 v105, v105
    ds_read_b64_tr_b16 v[202:203], v6 offset:2048
    ds_read_b64_tr_b16 v[206:207], v6 offset:3072
    s_setprio 2
    v_exp_f32 v106, v106
    v_exp_f32_e64 v107, v107
    v_smfmac_f32_32x32x32_bf16 v[16:31], v[196:199], v[88:95], v2
    v_exp_f32 v108, v108
    v_exp_f32 v109, v109
    v_exp_f32 v110, v110
    v_exp_f32 v111, v111
    v_mfma_f32_32x32x16_bf16 v[128:143], v[180:183], v[172:175], 4.0
    v_exp_f32 v112, v112
    v_exp_f32 v113, v113
    v_exp_f32 v114, v114
    v_exp_f32 v115, v115
    v_mfma_f32_32x32x16_bf16 v[128:143], v[176:179], v[168:171], v[128:143]
    v_exp_f32 v116, v116
    v_exp_f32 v117, v117
    v_exp_f32 v118, v118
    v_exp_f32 v119, v119
    v_smfmac_f32_32x32x32_bf16 v[32:47], v[192:195], v[96:103], v2
    v_exp_f32 v120, v120
    v_exp_f32 v121, v121
    v_exp_f32 v122, v122
    v_exp_f32 v123, v123
    v_smfmac_f32_32x32x32_bf16 v[32:47], v[196:199], v[104:111], v2
    v_exp_f32 v124, v124
    v_exp_f32 v125, v125
    ds_read_b64_tr_b16 v[204:205], v5 offset:3072
    v_exp_f32 v126, v126
    v_exp_f32 v127, v127
    s_setprio 1
    s_waitcnt lgkmcnt(1)
    v_mfma_f32_32x32x16_bf16 v[80:95], v[188:191], v[148:151], 4.0
    v_exp_f32 v128, v128
    v_exp_f32 v129, v129
    v_exp_f32 v130, v130
    v_exp_f32 v131, v131
    v_mfma_f32_32x32x16_bf16 v[80:95], v[184:187], v[144:147], v[80:95]
    v_exp_f32 v132, v132
    v_exp_f32 v133, v133
    v_exp_f32 v134, v134
    s_add_u32 m0, s35, 82176
    s_mov_b32 exec_hi, 0x00ffffff
    buffer_load_dwordx4 v8, s[16:19], s31 offen offset:1792 lds
    s_mov_b32 exec_hi, -1
    s_add_u32 s31, s31, 14336
    v_exp_f32_e64 v135, v135
    v_smfmac_f32_32x32x32_bf16 v[48:63], v[192:195], v[112:119], v2
    v_exp_f32 v136, v136
    v_exp_f32 v137, v137
    v_exp_f32 v138, v138
    v_exp_f32 v139, v139
    v_smfmac_f32_32x32x32_bf16 v[48:63], v[196:199], v[120:127], v2
    v_exp_f32 v140, v140
    v_exp_f32 v141, v141
    s_setprio 0
    v_exp_f32 v142, v142
    v_exp_f32_e64 v143, v143
    v_mfma_f32_32x32x16_bf16 v[96:111], v[188:191], v[156:159], 4.0
    v_exp_f32 v80, v80
    v_exp_f32 v81, v81
    v_exp_f32 v82, v82
    v_exp_f32 v83, v83
    v_mfma_f32_32x32x16_bf16 v[96:111], v[184:187], v[152:155], v[96:111]
    v_exp_f32 v84, v84
    s_waitcnt vmcnt(4) lgkmcnt(0)
    s_barrier
    v_exp_f32 v85, v85
    s_setprio 3
    v_exp_f32 v86, v86
    v_exp_f32_e64 v87, v87
    v_smfmac_f32_32x32x32_bf16 v[64:79], v[192:195], v[128:135], v2
    v_exp_f32 v88, v88
    v_exp_f32 v89, v89
    ds_read_b128 v[180:183], v3 offset:16384
    s_add_u32 m0, s35, 0
    s_nop 0
    buffer_load_dwordx4 v7, s[12:15], s31 offen lds
    v_exp_f32 v90, v90
    v_exp_f32 v91, v91
    v_smfmac_f32_32x32x32_bf16 v[64:79], v[196:199], v[136:143], v2
    v_exp_f32 v92, v92
    v_exp_f32 v93, v93
    v_exp_f32 v94, v94
    v_exp_f32 v95, v95
    v_mfma_f32_32x32x16_bf16 v[112:127], v[188:191], v[164:167], 4.0
    v_exp_f32 v96, v96
    v_exp_f32 v97, v97
    ds_read_b96 v[176:178], v4 offset:16384
    ds_read_b64_tr_b16 v[192:193], v5 offset:16384
    v_exp_f32 v98, v98
    v_exp_f32 v99, v99
    v_mfma_f32_32x32x16_bf16 v[112:127], v[184:187], v[160:163], v[112:127]
    v_exp_f32 v100, v100
    v_exp_f32 v101, v101
    v_exp_f32 v102, v102
    v_exp_f32 v103, v103
    v_smfmac_f32_32x32x32_bf16 v[16:31], v[200:203], v[80:87], v2
    v_exp_f32 v104, v104
    v_exp_f32 v105, v105
    v_exp_f32 v106, v106
    v_exp_f32 v107, v107
    ds_read_b64_tr_b16 v[194:195], v6 offset:16384
    ds_read_b64_tr_b16 v[196:197], v5 offset:17408
    ds_read_b64_tr_b16 v[198:199], v6 offset:17408
    v_smfmac_f32_32x32x32_bf16 v[16:31], v[204:207], v[88:95], v2
    v_exp_f32 v108, v108
    v_exp_f32 v109, v109
    v_exp_f32 v110, v110
    v_exp_f32 v111, v111
    v_mfma_f32_32x32x16_bf16 v[128:143], v[188:191], v[172:175], 4.0
    v_exp_f32 v112, v112
    v_exp_f32 v113, v113
    v_exp_f32 v114, v114
    v_exp_f32 v115, v115
    v_mfma_f32_32x32x16_bf16 v[128:143], v[184:187], v[168:171], v[128:143]
    v_exp_f32 v116, v116
    v_exp_f32 v117, v117
    v_exp_f32 v118, v118
    v_exp_f32 v119, v119
    v_smfmac_f32_32x32x32_bf16 v[32:47], v[200:203], v[96:103], v2
    v_exp_f32 v120, v120
    v_exp_f32 v121, v121
    s_add_u32 m0, s35, 49152
    s_mov_b32 exec_hi, 0x00ffffff
    buffer_load_dwordx4 v8, s[16:19], s31 offen lds
    s_mov_b32 exec_hi, -1
    v_exp_f32 v122, v122
    v_exp_f32_e64 v123, v123
    v_smfmac_f32_32x32x32_bf16 v[32:47], v[204:207], v[104:111], v2
    v_exp_f32 v124, v124
    v_exp_f32 v125, v125
    v_exp_f32 v126, v126
    v_exp_f32_e64 v127, v127
    s_waitcnt lgkmcnt(0)
    v_mfma_f32_32x32x16_bf16 v[80:95], v[180:183], v[148:151], 4.0
    v_exp_f32 v128, v128
    v_exp_f32 v129, v129
    v_exp_f32 v130, v130
    v_exp_f32 v131, v131
    v_mfma_f32_32x32x16_bf16 v[80:95], v[176:179], v[144:147], v[80:95]
    v_exp_f32 v132, v132
    v_exp_f32 v133, v133
    s_add_u32 m0, s35, 256
    s_nop 0
    buffer_load_dwordx4 v7, s[12:15], s31 offen offset:1792 lds
    v_exp_f32 v134, v134
    v_exp_f32_e64 v135, v135
    v_smfmac_f32_32x32x32_bf16 v[48:63], v[200:203], v[112:119], v2
    v_exp_f32 v136, v136
    v_exp_f32 v137, v137
    v_exp_f32 v138, v138
    v_exp_f32 v139, v139
    v_smfmac_f32_32x32x32_bf16 v[48:63], v[204:207], v[120:127], v2
    v_exp_f32 v140, v140
    v_exp_f32 v141, v141
    v_exp_f32 v142, v142
    v_exp_f32 v143, v143
    v_mfma_f32_32x32x16_bf16 v[96:111], v[180:183], v[156:159], 4.0
    v_exp_f32 v80, v80
    v_exp_f32 v81, v81
    v_exp_f32 v82, v82
    v_exp_f32 v83, v83
    v_mfma_f32_32x32x16_bf16 v[96:111], v[176:179], v[152:155], v[96:111]
    v_exp_f32 v84, v84
    v_exp_f32 v85, v85
    v_exp_f32 v86, v86
    v_exp_f32 v87, v87
    v_smfmac_f32_32x32x32_bf16 v[64:79], v[200:203], v[128:135], v2
    v_exp_f32 v88, v88
    v_exp_f32 v89, v89
    v_exp_f32 v90, v90
    v_exp_f32 v91, v91
    v_smfmac_f32_32x32x32_bf16 v[64:79], v[204:207], v[136:143], v2
    v_exp_f32 v92, v92
    v_exp_f32 v93, v93
    v_exp_f32 v94, v94
    v_exp_f32 v95, v95
    ds_read_b96 v[184:186], v4 offset:18432
    ds_read_b128 v[188:191], v3 offset:18432
    ds_read_b64_tr_b16 v[200:201], v5 offset:18432
    v_mfma_f32_32x32x16_bf16 v[112:127], v[180:183], v[164:167], 4.0
    v_exp_f32 v96, v96
    v_exp_f32 v97, v97
    v_exp_f32 v98, v98
    v_exp_f32 v99, v99
    v_mfma_f32_32x32x16_bf16 v[112:127], v[176:179], v[160:163], v[112:127]
    v_exp_f32 v100, v100
    v_exp_f32 v101, v101
    v_exp_f32 v102, v102
    v_exp_f32 v103, v103
    v_smfmac_f32_32x32x32_bf16 v[16:31], v[192:195], v[80:87], v2
    v_exp_f32 v104, v104
    v_exp_f32 v105, v105
    ds_read_b64_tr_b16 v[202:203], v6 offset:18432
    ds_read_b64_tr_b16 v[206:207], v6 offset:19456
    s_setprio 2
    v_exp_f32 v106, v106
    v_exp_f32_e64 v107, v107
    v_smfmac_f32_32x32x32_bf16 v[16:31], v[196:199], v[88:95], v2
    v_exp_f32 v108, v108
    v_exp_f32 v109, v109
    v_exp_f32 v110, v110
    v_exp_f32 v111, v111
    v_mfma_f32_32x32x16_bf16 v[128:143], v[180:183], v[172:175], 4.0
    v_exp_f32 v112, v112
    v_exp_f32 v113, v113
    v_exp_f32 v114, v114
    v_exp_f32 v115, v115
    v_mfma_f32_32x32x16_bf16 v[128:143], v[176:179], v[168:171], v[128:143]
    v_exp_f32 v116, v116
    v_exp_f32 v117, v117
    v_exp_f32 v118, v118
    v_exp_f32 v119, v119
    v_smfmac_f32_32x32x32_bf16 v[32:47], v[192:195], v[96:103], v2
    v_exp_f32 v120, v120
    v_exp_f32 v121, v121
    v_exp_f32 v122, v122
    v_exp_f32 v123, v123
    v_smfmac_f32_32x32x32_bf16 v[32:47], v[196:199], v[104:111], v2
    v_exp_f32 v124, v124
    v_exp_f32 v125, v125
    ds_read_b64_tr_b16 v[204:205], v5 offset:19456
    v_exp_f32 v126, v126
    v_exp_f32 v127, v127
    s_setprio 1
    s_waitcnt lgkmcnt(1)
    v_mfma_f32_32x32x16_bf16 v[80:95], v[188:191], v[148:151], 4.0
    v_exp_f32 v128, v128
    v_exp_f32 v129, v129
    v_exp_f32 v130, v130
    v_exp_f32 v131, v131
    v_mfma_f32_32x32x16_bf16 v[80:95], v[184:187], v[144:147], v[80:95]
    v_exp_f32 v132, v132
    v_exp_f32 v133, v133
    v_exp_f32 v134, v134
    s_add_u32 m0, s35, 49408
    s_mov_b32 exec_hi, 0x00ffffff
    buffer_load_dwordx4 v8, s[16:19], s31 offen offset:1792 lds
    s_mov_b32 exec_hi, -1
    s_add_u32 s31, s31, 14336
    v_exp_f32_e64 v135, v135
    v_smfmac_f32_32x32x32_bf16 v[48:63], v[192:195], v[112:119], v2
    v_exp_f32 v136, v136
    v_exp_f32 v137, v137
    v_exp_f32 v138, v138
    v_exp_f32 v139, v139
    v_smfmac_f32_32x32x32_bf16 v[48:63], v[196:199], v[120:127], v2
    v_exp_f32 v140, v140
    v_exp_f32 v141, v141
    s_setprio 0
    v_exp_f32 v142, v142
    v_exp_f32_e64 v143, v143
    v_mfma_f32_32x32x16_bf16 v[96:111], v[188:191], v[156:159], 4.0
    v_exp_f32 v80, v80
    v_exp_f32 v81, v81
    v_exp_f32 v82, v82
    v_exp_f32 v83, v83
    v_mfma_f32_32x32x16_bf16 v[96:111], v[184:187], v[152:155], v[96:111]
    v_exp_f32 v84, v84
    s_waitcnt vmcnt(4) lgkmcnt(0)
    s_barrier
    v_exp_f32 v85, v85
    s_setprio 3
    v_exp_f32 v86, v86
    v_exp_f32_e64 v87, v87
    v_smfmac_f32_32x32x32_bf16 v[64:79], v[192:195], v[128:135], v2
    v_exp_f32 v88, v88
    v_exp_f32 v89, v89
    ds_read_b128 v[180:183], v3 offset:32768
    s_add_u32 m0, s35, 16384
    s_nop 0
    buffer_load_dwordx4 v7, s[12:15], s31 offen lds
    v_exp_f32 v90, v90
    v_exp_f32_e64 v91, v91
    v_smfmac_f32_32x32x32_bf16 v[64:79], v[196:199], v[136:143], v2
    v_exp_f32 v92, v92
    v_exp_f32 v93, v93
    v_exp_f32 v94, v94
    v_exp_f32 v95, v95
    v_mfma_f32_32x32x16_bf16 v[112:127], v[188:191], v[164:167], 4.0
    v_exp_f32 v96, v96
    v_exp_f32 v97, v97
    ds_read_b96 v[176:178], v4 offset:32768
    ds_read_b64_tr_b16 v[192:193], v5 offset:32768
    v_exp_f32 v98, v98
    v_exp_f32 v99, v99
    v_mfma_f32_32x32x16_bf16 v[112:127], v[184:187], v[160:163], v[112:127]
    v_exp_f32 v100, v100
    v_exp_f32 v101, v101
    v_exp_f32 v102, v102
    v_exp_f32 v103, v103
    v_smfmac_f32_32x32x32_bf16 v[16:31], v[200:203], v[80:87], v2
    v_exp_f32 v104, v104
    v_exp_f32 v105, v105
    v_exp_f32 v106, v106
    v_exp_f32 v107, v107
    ds_read_b64_tr_b16 v[194:195], v6 offset:32768
    ds_read_b64_tr_b16 v[196:197], v5 offset:33792
    ds_read_b64_tr_b16 v[198:199], v6 offset:33792
    v_smfmac_f32_32x32x32_bf16 v[16:31], v[204:207], v[88:95], v2
    v_exp_f32 v108, v108
    v_exp_f32 v109, v109
    v_exp_f32 v110, v110
    v_exp_f32 v111, v111
    v_mfma_f32_32x32x16_bf16 v[128:143], v[188:191], v[172:175], 4.0
    v_exp_f32 v112, v112
    v_exp_f32 v113, v113
    v_exp_f32 v114, v114
    v_exp_f32 v115, v115
    v_mfma_f32_32x32x16_bf16 v[128:143], v[184:187], v[168:171], v[128:143]
    v_exp_f32 v116, v116
    v_exp_f32 v117, v117
    v_exp_f32 v118, v118
    v_exp_f32 v119, v119
    v_smfmac_f32_32x32x32_bf16 v[32:47], v[200:203], v[96:103], v2
    v_exp_f32 v120, v120
    v_exp_f32 v121, v121
    s_add_u32 m0, s35, 65536
    s_mov_b32 exec_hi, 0x00ffffff
    buffer_load_dwordx4 v8, s[16:19], s31 offen lds
    s_mov_b32 exec_hi, -1
    v_exp_f32 v122, v122
    v_exp_f32_e64 v123, v123
    v_smfmac_f32_32x32x32_bf16 v[32:47], v[204:207], v[104:111], v2
    v_exp_f32 v124, v124
    v_exp_f32 v125, v125
    v_exp_f32 v126, v126
    v_exp_f32_e64 v127, v127
    s_waitcnt lgkmcnt(0)
    v_mfma_f32_32x32x16_bf16 v[80:95], v[180:183], v[148:151], 4.0
    v_exp_f32 v128, v128
    v_exp_f32 v129, v129
    v_exp_f32 v130, v130
    v_exp_f32 v131, v131
    v_mfma_f32_32x32x16_bf16 v[80:95], v[176:179], v[144:147], v[80:95]
    v_exp_f32 v132, v132
    v_exp_f32 v133, v133
    s_add_u32 m0, s35, 16640
    s_nop 0
    buffer_load_dwordx4 v7, s[12:15], s31 offen offset:1792 lds
    v_exp_f32 v134, v134
    v_exp_f32_e64 v135, v135
    v_smfmac_f32_32x32x32_bf16 v[48:63], v[200:203], v[112:119], v2
    v_exp_f32 v136, v136
    v_exp_f32 v137, v137
    v_exp_f32 v138, v138
    v_exp_f32 v139, v139
    v_smfmac_f32_32x32x32_bf16 v[48:63], v[204:207], v[120:127], v2
    v_exp_f32 v140, v140
    v_exp_f32 v141, v141
    v_exp_f32 v142, v142
    v_exp_f32 v143, v143
    v_mfma_f32_32x32x16_bf16 v[96:111], v[180:183], v[156:159], 4.0
    v_exp_f32 v80, v80
    v_exp_f32 v81, v81
    v_exp_f32 v82, v82
    v_exp_f32 v83, v83
    v_mfma_f32_32x32x16_bf16 v[96:111], v[176:179], v[152:155], v[96:111]
    v_exp_f32 v84, v84
    v_exp_f32 v85, v85
    v_exp_f32 v86, v86
    v_exp_f32 v87, v87
    v_smfmac_f32_32x32x32_bf16 v[64:79], v[200:203], v[128:135], v2
    v_exp_f32 v88, v88
    v_exp_f32 v89, v89
    v_exp_f32 v90, v90
    v_exp_f32 v91, v91
    v_smfmac_f32_32x32x32_bf16 v[64:79], v[204:207], v[136:143], v2
    v_exp_f32 v92, v92
    v_exp_f32 v93, v93
    v_exp_f32 v94, v94
    v_exp_f32 v95, v95
    ds_read_b96 v[184:186], v4 offset:34816
    ds_read_b128 v[188:191], v3 offset:34816
    ds_read_b64_tr_b16 v[200:201], v5 offset:34816
    v_mfma_f32_32x32x16_bf16 v[112:127], v[180:183], v[164:167], 4.0
    v_exp_f32 v96, v96
    v_exp_f32 v97, v97
    v_exp_f32 v98, v98
    v_exp_f32 v99, v99
    v_mfma_f32_32x32x16_bf16 v[112:127], v[176:179], v[160:163], v[112:127]
    v_exp_f32 v100, v100
    v_exp_f32 v101, v101
    v_exp_f32 v102, v102
    v_exp_f32 v103, v103
    v_smfmac_f32_32x32x32_bf16 v[16:31], v[192:195], v[80:87], v2
    v_exp_f32 v104, v104
    v_exp_f32 v105, v105
    ds_read_b64_tr_b16 v[202:203], v6 offset:34816
    ds_read_b64_tr_b16 v[206:207], v6 offset:35840
    s_setprio 2
    v_exp_f32 v106, v106
    v_exp_f32_e64 v107, v107
    v_smfmac_f32_32x32x32_bf16 v[16:31], v[196:199], v[88:95], v2
    v_exp_f32 v108, v108
    v_exp_f32 v109, v109
    v_exp_f32 v110, v110
    v_exp_f32 v111, v111
    v_mfma_f32_32x32x16_bf16 v[128:143], v[180:183], v[172:175], 4.0
    v_exp_f32 v112, v112
    v_exp_f32 v113, v113
    v_exp_f32 v114, v114
    v_exp_f32 v115, v115
    v_mfma_f32_32x32x16_bf16 v[128:143], v[176:179], v[168:171], v[128:143]
    v_exp_f32 v116, v116
    v_exp_f32 v117, v117
    v_exp_f32 v118, v118
    v_exp_f32 v119, v119
    v_smfmac_f32_32x32x32_bf16 v[32:47], v[192:195], v[96:103], v2
    v_exp_f32 v120, v120
    v_exp_f32 v121, v121
    v_exp_f32 v122, v122
    v_exp_f32 v123, v123
    v_smfmac_f32_32x32x32_bf16 v[32:47], v[196:199], v[104:111], v2
    v_exp_f32 v124, v124
    v_exp_f32 v125, v125
    ds_read_b64_tr_b16 v[204:205], v5 offset:35840
    v_exp_f32 v126, v126
    v_exp_f32 v127, v127
    s_setprio 1
    s_waitcnt lgkmcnt(1)
    v_mfma_f32_32x32x16_bf16 v[80:95], v[188:191], v[148:151], 4.0
    v_exp_f32 v128, v128
    v_exp_f32 v129, v129
    v_exp_f32 v130, v130
    v_exp_f32 v131, v131
    v_mfma_f32_32x32x16_bf16 v[80:95], v[184:187], v[144:147], v[80:95]
    v_exp_f32 v132, v132
    v_exp_f32 v133, v133
    v_exp_f32 v134, v134
    s_add_u32 m0, s35, 65792
    s_mov_b32 exec_hi, 0x00ffffff
    buffer_load_dwordx4 v8, s[16:19], s31 offen offset:1792 lds
    s_mov_b32 exec_hi, -1
    s_add_u32 s31, s31, 14336
    v_exp_f32_e64 v135, v135
    v_smfmac_f32_32x32x32_bf16 v[48:63], v[192:195], v[112:119], v2
    v_exp_f32 v136, v136
    v_exp_f32 v137, v137
    v_exp_f32 v138, v138
    v_exp_f32 v139, v139
    v_smfmac_f32_32x32x32_bf16 v[48:63], v[196:199], v[120:127], v2
    v_exp_f32 v140, v140
    v_exp_f32 v141, v141
    s_setprio 0
    v_exp_f32 v142, v142
    v_exp_f32_e64 v143, v143
    v_mfma_f32_32x32x16_bf16 v[96:111], v[188:191], v[156:159], 4.0
    v_exp_f32 v80, v80
    v_exp_f32 v81, v81
    v_exp_f32 v82, v82
    v_exp_f32 v83, v83
    v_mfma_f32_32x32x16_bf16 v[96:111], v[184:187], v[152:155], v[96:111]
    v_exp_f32 v84, v84
    s_waitcnt vmcnt(4) lgkmcnt(0)
    s_barrier
    v_exp_f32 v85, v85
    s_setprio 3
    v_exp_f32 v86, v86
    v_exp_f32_e64 v87, v87
    v_smfmac_f32_32x32x32_bf16 v[64:79], v[192:195], v[128:135], v2
    v_exp_f32 v88, v88
    v_exp_f32 v89, v89
    ds_read_b128 v[180:183], v3 offset:0
    s_add_u32 m0, s35, 32768
    s_nop 0
    buffer_load_dwordx4 v7, s[12:15], s31 offen lds
    v_exp_f32 v90, v90
    v_exp_f32_e64 v91, v91
    v_smfmac_f32_32x32x32_bf16 v[64:79], v[196:199], v[136:143], v2
    v_exp_f32 v92, v92
    v_exp_f32 v93, v93
    v_exp_f32 v94, v94
    v_exp_f32 v95, v95
    v_mfma_f32_32x32x16_bf16 v[112:127], v[188:191], v[164:167], 4.0
    v_exp_f32 v96, v96
    v_exp_f32 v97, v97
    ds_read_b96 v[176:178], v4 offset:0
    ds_read_b64_tr_b16 v[192:193], v5 offset:0
    v_exp_f32 v98, v98
    v_exp_f32 v99, v99
    v_mfma_f32_32x32x16_bf16 v[112:127], v[184:187], v[160:163], v[112:127]
    v_exp_f32 v100, v100
    v_exp_f32 v101, v101
    v_exp_f32 v102, v102
    v_exp_f32 v103, v103
    v_smfmac_f32_32x32x32_bf16 v[16:31], v[200:203], v[80:87], v2
    v_exp_f32 v104, v104
    v_exp_f32 v105, v105
    v_exp_f32 v106, v106
    v_exp_f32 v107, v107
    ds_read_b64_tr_b16 v[194:195], v6 offset:0
    ds_read_b64_tr_b16 v[196:197], v5 offset:1024
    ds_read_b64_tr_b16 v[198:199], v6 offset:1024
    v_smfmac_f32_32x32x32_bf16 v[16:31], v[204:207], v[88:95], v2
    v_exp_f32 v108, v108
    v_exp_f32 v109, v109
    v_exp_f32 v110, v110
    v_exp_f32 v111, v111
    v_mfma_f32_32x32x16_bf16 v[128:143], v[188:191], v[172:175], 4.0
    v_exp_f32 v112, v112
    v_exp_f32 v113, v113
    v_exp_f32 v114, v114
    v_exp_f32 v115, v115
    v_mfma_f32_32x32x16_bf16 v[128:143], v[184:187], v[168:171], v[128:143]
    v_exp_f32 v116, v116
    v_exp_f32 v117, v117
    v_exp_f32 v118, v118
    v_exp_f32 v119, v119
    v_smfmac_f32_32x32x32_bf16 v[32:47], v[200:203], v[96:103], v2
    v_exp_f32 v120, v120
    v_exp_f32 v121, v121
    s_add_u32 m0, s35, 81920
    s_mov_b32 exec_hi, 0x00ffffff
    buffer_load_dwordx4 v8, s[16:19], s31 offen lds
    s_mov_b32 exec_hi, -1
    v_exp_f32 v122, v122
    v_exp_f32_e64 v123, v123
    v_smfmac_f32_32x32x32_bf16 v[32:47], v[204:207], v[104:111], v2
    v_exp_f32 v124, v124
    v_exp_f32 v125, v125
    v_exp_f32 v126, v126
    v_exp_f32_e64 v127, v127
    s_waitcnt lgkmcnt(0)
    v_mfma_f32_32x32x16_bf16 v[80:95], v[180:183], v[148:151], 4.0
    v_exp_f32 v128, v128
    v_exp_f32 v129, v129
    v_exp_f32 v130, v130
    v_exp_f32 v131, v131
    v_mfma_f32_32x32x16_bf16 v[80:95], v[176:179], v[144:147], v[80:95]
    v_exp_f32 v132, v132
    v_exp_f32 v133, v133
    s_add_u32 m0, s35, 33024
    s_nop 0
    buffer_load_dwordx4 v7, s[12:15], s31 offen offset:1792 lds
    v_exp_f32 v134, v134
    v_exp_f32_e64 v135, v135
    v_smfmac_f32_32x32x32_bf16 v[48:63], v[200:203], v[112:119], v2
    v_exp_f32 v136, v136
    v_exp_f32 v137, v137
    v_exp_f32 v138, v138
    v_exp_f32 v139, v139
    v_smfmac_f32_32x32x32_bf16 v[48:63], v[204:207], v[120:127], v2
    v_exp_f32 v140, v140
    v_exp_f32 v141, v141
    v_exp_f32 v142, v142
    v_exp_f32 v143, v143
    v_mfma_f32_32x32x16_bf16 v[96:111], v[180:183], v[156:159], 4.0
    v_exp_f32 v80, v80
    v_exp_f32 v81, v81
    v_exp_f32 v82, v82
    v_exp_f32 v83, v83
    v_mfma_f32_32x32x16_bf16 v[96:111], v[176:179], v[152:155], v[96:111]
    v_exp_f32 v84, v84
    v_exp_f32 v85, v85
    v_exp_f32 v86, v86
    v_exp_f32 v87, v87
    v_smfmac_f32_32x32x32_bf16 v[64:79], v[200:203], v[128:135], v2
    v_exp_f32 v88, v88
    v_exp_f32 v89, v89
    v_exp_f32 v90, v90
    v_exp_f32 v91, v91
    v_smfmac_f32_32x32x32_bf16 v[64:79], v[204:207], v[136:143], v2
    v_exp_f32 v92, v92
    v_exp_f32 v93, v93
    v_exp_f32 v94, v94
    v_exp_f32 v95, v95
    ds_read_b96 v[184:186], v4 offset:2048
    ds_read_b128 v[188:191], v3 offset:2048
    ds_read_b64_tr_b16 v[200:201], v5 offset:2048
    v_mfma_f32_32x32x16_bf16 v[112:127], v[180:183], v[164:167], 4.0
    v_exp_f32 v96, v96
    v_exp_f32 v97, v97
    v_exp_f32 v98, v98
    v_exp_f32 v99, v99
    v_mfma_f32_32x32x16_bf16 v[112:127], v[176:179], v[160:163], v[112:127]
    v_exp_f32 v100, v100
    v_exp_f32 v101, v101
    v_exp_f32 v102, v102
    v_exp_f32 v103, v103
    v_smfmac_f32_32x32x32_bf16 v[16:31], v[192:195], v[80:87], v2
    v_exp_f32 v104, v104
    v_exp_f32 v105, v105
    ds_read_b64_tr_b16 v[202:203], v6 offset:2048
    ds_read_b64_tr_b16 v[206:207], v6 offset:3072
    s_setprio 2
    v_exp_f32 v106, v106
    v_exp_f32_e64 v107, v107
    v_smfmac_f32_32x32x32_bf16 v[16:31], v[196:199], v[88:95], v2
    v_exp_f32 v108, v108
    v_exp_f32 v109, v109
    v_exp_f32 v110, v110
    v_exp_f32 v111, v111
    v_mfma_f32_32x32x16_bf16 v[128:143], v[180:183], v[172:175], 4.0
    v_exp_f32 v112, v112
    v_exp_f32 v113, v113
    v_exp_f32 v114, v114
    v_exp_f32 v115, v115
    v_mfma_f32_32x32x16_bf16 v[128:143], v[176:179], v[168:171], v[128:143]
    v_exp_f32 v116, v116
    v_exp_f32 v117, v117
    v_exp_f32 v118, v118
    v_exp_f32 v119, v119
    v_smfmac_f32_32x32x32_bf16 v[32:47], v[192:195], v[96:103], v2
    v_exp_f32 v120, v120
    v_exp_f32 v121, v121
    v_exp_f32 v122, v122
    v_exp_f32 v123, v123
    v_smfmac_f32_32x32x32_bf16 v[32:47], v[196:199], v[104:111], v2
    v_exp_f32 v124, v124
    v_exp_f32 v125, v125
    ds_read_b64_tr_b16 v[204:205], v5 offset:3072
    v_exp_f32 v126, v126
    v_exp_f32 v127, v127
    s_setprio 1
    s_waitcnt lgkmcnt(1)
    v_mfma_f32_32x32x16_bf16 v[80:95], v[188:191], v[148:151], 4.0
    v_exp_f32 v128, v128
    v_exp_f32 v129, v129
    v_exp_f32 v130, v130
    v_exp_f32 v131, v131
    v_mfma_f32_32x32x16_bf16 v[80:95], v[184:187], v[144:147], v[80:95]
    v_exp_f32 v132, v132
    v_exp_f32 v133, v133
    v_exp_f32 v134, v134
    s_add_u32 m0, s35, 82176
    s_mov_b32 exec_hi, 0x00ffffff
    buffer_load_dwordx4 v8, s[16:19], s31 offen offset:1792 lds
    s_mov_b32 exec_hi, -1
    s_add_u32 s31, s31, 14336
    v_exp_f32_e64 v135, v135
    v_smfmac_f32_32x32x32_bf16 v[48:63], v[192:195], v[112:119], v2
    v_exp_f32 v136, v136
    v_exp_f32 v137, v137
    v_exp_f32 v138, v138
    v_exp_f32 v139, v139
    v_smfmac_f32_32x32x32_bf16 v[48:63], v[196:199], v[120:127], v2
    v_exp_f32 v140, v140
    v_exp_f32 v141, v141
    s_setprio 0
    v_exp_f32 v142, v142
    v_exp_f32_e64 v143, v143
    v_mfma_f32_32x32x16_bf16 v[96:111], v[188:191], v[156:159], 4.0
    v_exp_f32 v80, v80
    v_exp_f32 v81, v81
    v_exp_f32 v82, v82
    v_exp_f32 v83, v83
    v_mfma_f32_32x32x16_bf16 v[96:111], v[184:187], v[152:155], v[96:111]
    v_exp_f32 v84, v84
    s_waitcnt vmcnt(4) lgkmcnt(0)
    s_barrier
    v_exp_f32 v85, v85
    s_setprio 3
    v_exp_f32 v86, v86
    v_exp_f32_e64 v87, v87
    v_smfmac_f32_32x32x32_bf16 v[64:79], v[192:195], v[128:135], v2
    v_exp_f32 v88, v88
    v_exp_f32 v89, v89
    ds_read_b128 v[180:183], v3 offset:16384
    s_add_u32 m0, s35, 0
    s_nop 0
    buffer_load_dwordx4 v7, s[12:15], s31 offen lds
    v_exp_f32 v90, v90
    v_exp_f32 v91, v91
    v_smfmac_f32_32x32x32_bf16 v[64:79], v[196:199], v[136:143], v2
    v_exp_f32 v92, v92
    v_exp_f32 v93, v93
    v_exp_f32 v94, v94
    v_exp_f32 v95, v95
    v_mfma_f32_32x32x16_bf16 v[112:127], v[188:191], v[164:167], 4.0
    v_exp_f32 v96, v96
    v_exp_f32 v97, v97
    ds_read_b96 v[176:178], v4 offset:16384
    ds_read_b64_tr_b16 v[192:193], v5 offset:16384
    v_exp_f32 v98, v98
    v_exp_f32 v99, v99
    v_mfma_f32_32x32x16_bf16 v[112:127], v[184:187], v[160:163], v[112:127]
    v_exp_f32 v100, v100
    v_exp_f32 v101, v101
    v_exp_f32 v102, v102
    v_exp_f32 v103, v103
    v_smfmac_f32_32x32x32_bf16 v[16:31], v[200:203], v[80:87], v2
    v_exp_f32 v104, v104
    v_exp_f32 v105, v105
    v_exp_f32 v106, v106
    v_exp_f32 v107, v107
    ds_read_b64_tr_b16 v[194:195], v6 offset:16384
    ds_read_b64_tr_b16 v[196:197], v5 offset:17408
    ds_read_b64_tr_b16 v[198:199], v6 offset:17408
    v_smfmac_f32_32x32x32_bf16 v[16:31], v[204:207], v[88:95], v2
    v_exp_f32 v108, v108
    v_exp_f32 v109, v109
    v_exp_f32 v110, v110
    v_exp_f32 v111, v111
    v_mfma_f32_32x32x16_bf16 v[128:143], v[188:191], v[172:175], 4.0
    v_exp_f32 v112, v112
    v_exp_f32 v113, v113
    v_exp_f32 v114, v114
    v_exp_f32 v115, v115
    v_mfma_f32_32x32x16_bf16 v[128:143], v[184:187], v[168:171], v[128:143]
    v_exp_f32 v116, v116
    v_exp_f32 v117, v117
    v_exp_f32 v118, v118
    v_exp_f32 v119, v119
    v_smfmac_f32_32x32x32_bf16 v[32:47], v[200:203], v[96:103], v2
    v_exp_f32 v120, v120
    v_exp_f32 v121, v121
    s_add_u32 m0, s35, 49152
    s_mov_b32 exec_hi, 0x00ffffff
    buffer_load_dwordx4 v8, s[16:19], s31 offen lds
    s_mov_b32 exec_hi, -1
    v_exp_f32 v122, v122
    v_exp_f32_e64 v123, v123
    v_smfmac_f32_32x32x32_bf16 v[32:47], v[204:207], v[104:111], v2
    v_exp_f32 v124, v124
    v_exp_f32 v125, v125
    v_exp_f32 v126, v126
    v_exp_f32_e64 v127, v127
    s_waitcnt lgkmcnt(0)
    v_mfma_f32_32x32x16_bf16 v[80:95], v[180:183], v[148:151], 4.0
    v_exp_f32 v128, v128
    v_exp_f32 v129, v129
    v_exp_f32 v130, v130
    v_exp_f32 v131, v131
    v_mfma_f32_32x32x16_bf16 v[80:95], v[176:179], v[144:147], v[80:95]
    v_exp_f32 v132, v132
    v_exp_f32 v133, v133
    s_add_u32 m0, s35, 256
    s_nop 0
    buffer_load_dwordx4 v7, s[12:15], s31 offen offset:1792 lds
    v_exp_f32 v134, v134
    v_exp_f32_e64 v135, v135
    v_smfmac_f32_32x32x32_bf16 v[48:63], v[200:203], v[112:119], v2
    v_exp_f32 v136, v136
    v_exp_f32 v137, v137
    v_exp_f32 v138, v138
    v_exp_f32 v139, v139
    v_smfmac_f32_32x32x32_bf16 v[48:63], v[204:207], v[120:127], v2
    v_exp_f32 v140, v140
    v_exp_f32 v141, v141
    v_exp_f32 v142, v142
    v_exp_f32 v143, v143
    v_mfma_f32_32x32x16_bf16 v[96:111], v[180:183], v[156:159], 4.0
    v_exp_f32 v80, v80
    v_exp_f32 v81, v81
    v_exp_f32 v82, v82
    v_exp_f32 v83, v83
    v_mfma_f32_32x32x16_bf16 v[96:111], v[176:179], v[152:155], v[96:111]
    v_exp_f32 v84, v84
    v_exp_f32 v85, v85
    v_exp_f32 v86, v86
    v_exp_f32 v87, v87
    v_smfmac_f32_32x32x32_bf16 v[64:79], v[200:203], v[128:135], v2
    v_exp_f32 v88, v88
    v_exp_f32 v89, v89
    v_exp_f32 v90, v90
    v_exp_f32 v91, v91
    v_smfmac_f32_32x32x32_bf16 v[64:79], v[204:207], v[136:143], v2
    v_exp_f32 v92, v92
    v_exp_f32 v93, v93
    v_exp_f32 v94, v94
    v_exp_f32 v95, v95
    ds_read_b96 v[184:186], v4 offset:18432
    ds_read_b128 v[188:191], v3 offset:18432
    ds_read_b64_tr_b16 v[200:201], v5 offset:18432
    v_mfma_f32_32x32x16_bf16 v[112:127], v[180:183], v[164:167], 4.0
    v_exp_f32 v96, v96
    v_exp_f32 v97, v97
    v_exp_f32 v98, v98
    v_exp_f32 v99, v99
    v_mfma_f32_32x32x16_bf16 v[112:127], v[176:179], v[160:163], v[112:127]
    v_exp_f32 v100, v100
    v_exp_f32 v101, v101
    v_exp_f32 v102, v102
    v_exp_f32 v103, v103
    v_smfmac_f32_32x32x32_bf16 v[16:31], v[192:195], v[80:87], v2
    v_exp_f32 v104, v104
    v_exp_f32 v105, v105
    ds_read_b64_tr_b16 v[202:203], v6 offset:18432
    ds_read_b64_tr_b16 v[206:207], v6 offset:19456
    s_setprio 2
    v_exp_f32 v106, v106
    v_exp_f32_e64 v107, v107
    v_smfmac_f32_32x32x32_bf16 v[16:31], v[196:199], v[88:95], v2
    v_exp_f32 v108, v108
    v_exp_f32 v109, v109
    v_exp_f32 v110, v110
    v_exp_f32 v111, v111
    v_mfma_f32_32x32x16_bf16 v[128:143], v[180:183], v[172:175], 4.0
    v_exp_f32 v112, v112
    v_exp_f32 v113, v113
    v_exp_f32 v114, v114
    v_exp_f32 v115, v115
    v_mfma_f32_32x32x16_bf16 v[128:143], v[176:179], v[168:171], v[128:143]
    v_exp_f32 v116, v116
    v_exp_f32 v117, v117
    v_exp_f32 v118, v118
    v_exp_f32 v119, v119
    v_smfmac_f32_32x32x32_bf16 v[32:47], v[192:195], v[96:103], v2
    v_exp_f32 v120, v120
    v_exp_f32 v121, v121
    v_exp_f32 v122, v122
    v_exp_f32 v123, v123
    v_smfmac_f32_32x32x32_bf16 v[32:47], v[196:199], v[104:111], v2
    v_exp_f32 v124, v124
    v_exp_f32 v125, v125
    ds_read_b64_tr_b16 v[204:205], v5 offset:19456
    v_exp_f32 v126, v126
    v_exp_f32 v127, v127
    s_setprio 1
    s_waitcnt lgkmcnt(1)
    v_mfma_f32_32x32x16_bf16 v[80:95], v[188:191], v[148:151], 4.0
    v_exp_f32 v128, v128
    v_exp_f32 v129, v129
    v_exp_f32 v130, v130
    v_exp_f32 v131, v131
    v_mfma_f32_32x32x16_bf16 v[80:95], v[184:187], v[144:147], v[80:95]
    v_exp_f32 v132, v132
    v_exp_f32 v133, v133
    v_exp_f32 v134, v134
    s_add_u32 m0, s35, 49408
    s_mov_b32 exec_hi, 0x00ffffff
    buffer_load_dwordx4 v8, s[16:19], s31 offen offset:1792 lds
    s_mov_b32 exec_hi, -1
    s_add_u32 s31, s31, 14336
    v_exp_f32_e64 v135, v135
    v_smfmac_f32_32x32x32_bf16 v[48:63], v[192:195], v[112:119], v2
    v_exp_f32 v136, v136
    v_exp_f32 v137, v137
    v_exp_f32 v138, v138
    v_exp_f32 v139, v139
    v_smfmac_f32_32x32x32_bf16 v[48:63], v[196:199], v[120:127], v2
    v_exp_f32 v140, v140
    v_exp_f32 v141, v141
    s_setprio 0
    v_exp_f32 v142, v142
    v_exp_f32_e64 v143, v143
    v_mfma_f32_32x32x16_bf16 v[96:111], v[188:191], v[156:159], 4.0
    v_exp_f32 v80, v80
    v_exp_f32 v81, v81
    v_exp_f32 v82, v82
    v_exp_f32 v83, v83
    v_mfma_f32_32x32x16_bf16 v[96:111], v[184:187], v[152:155], v[96:111]
    v_exp_f32 v84, v84
    s_waitcnt vmcnt(4) lgkmcnt(0)
    s_barrier
    v_exp_f32 v85, v85
    s_setprio 3
    v_exp_f32 v86, v86
    v_exp_f32_e64 v87, v87
    v_smfmac_f32_32x32x32_bf16 v[64:79], v[192:195], v[128:135], v2
    v_exp_f32 v88, v88
    v_exp_f32 v89, v89
    ds_read_b128 v[180:183], v3 offset:32768
    s_add_u32 m0, s35, 16384
    s_nop 0
    buffer_load_dwordx4 v7, s[12:15], s31 offen lds
    v_exp_f32 v90, v90
    v_exp_f32_e64 v91, v91
    v_smfmac_f32_32x32x32_bf16 v[64:79], v[196:199], v[136:143], v2
    v_exp_f32 v92, v92
    v_exp_f32 v93, v93
    v_exp_f32 v94, v94
    v_exp_f32 v95, v95
    v_mfma_f32_32x32x16_bf16 v[112:127], v[188:191], v[164:167], 4.0
    v_exp_f32 v96, v96
    v_exp_f32 v97, v97
    ds_read_b96 v[176:178], v4 offset:32768
    ds_read_b64_tr_b16 v[192:193], v5 offset:32768
    v_exp_f32 v98, v98
    v_exp_f32 v99, v99
    v_mfma_f32_32x32x16_bf16 v[112:127], v[184:187], v[160:163], v[112:127]
    v_exp_f32 v100, v100
    v_exp_f32 v101, v101
    v_exp_f32 v102, v102
    v_exp_f32 v103, v103
    v_smfmac_f32_32x32x32_bf16 v[16:31], v[200:203], v[80:87], v2
    v_exp_f32 v104, v104
    v_exp_f32 v105, v105
    v_exp_f32 v106, v106
    v_exp_f32 v107, v107
    ds_read_b64_tr_b16 v[194:195], v6 offset:32768
    ds_read_b64_tr_b16 v[196:197], v5 offset:33792
    ds_read_b64_tr_b16 v[198:199], v6 offset:33792
    v_smfmac_f32_32x32x32_bf16 v[16:31], v[204:207], v[88:95], v2
    v_exp_f32 v108, v108
    v_exp_f32 v109, v109
    v_exp_f32 v110, v110
    v_exp_f32 v111, v111
    v_mfma_f32_32x32x16_bf16 v[128:143], v[188:191], v[172:175], 4.0
    v_exp_f32 v112, v112
    v_exp_f32 v113, v113
    v_exp_f32 v114, v114
    v_exp_f32 v115, v115
    v_mfma_f32_32x32x16_bf16 v[128:143], v[184:187], v[168:171], v[128:143]
    v_exp_f32 v116, v116
    v_exp_f32 v117, v117
    v_exp_f32 v118, v118
    v_exp_f32 v119, v119
    v_smfmac_f32_32x32x32_bf16 v[32:47], v[200:203], v[96:103], v2
    v_exp_f32 v120, v120
    v_exp_f32 v121, v121
    s_add_u32 m0, s35, 65536
    s_mov_b32 exec_hi, 0x00ffffff
    buffer_load_dwordx4 v8, s[16:19], s31 offen lds
    s_mov_b32 exec_hi, -1
    v_exp_f32 v122, v122
    v_exp_f32_e64 v123, v123
    v_smfmac_f32_32x32x32_bf16 v[32:47], v[204:207], v[104:111], v2
    v_exp_f32 v124, v124
    v_exp_f32 v125, v125
    v_exp_f32 v126, v126
    v_exp_f32_e64 v127, v127
    s_waitcnt lgkmcnt(0)
    v_mfma_f32_32x32x16_bf16 v[80:95], v[180:183], v[148:151], 4.0
    v_exp_f32 v128, v128
    v_exp_f32 v129, v129
    v_exp_f32 v130, v130
    v_exp_f32 v131, v131
    v_mfma_f32_32x32x16_bf16 v[80:95], v[176:179], v[144:147], v[80:95]
    v_exp_f32 v132, v132
    v_exp_f32 v133, v133
    s_add_u32 m0, s35, 16640
    s_nop 0
    buffer_load_dwordx4 v7, s[12:15], s31 offen offset:1792 lds
    v_exp_f32 v134, v134
    v_exp_f32_e64 v135, v135
    v_smfmac_f32_32x32x32_bf16 v[48:63], v[200:203], v[112:119], v2
    v_exp_f32 v136, v136
    v_exp_f32 v137, v137
    v_exp_f32 v138, v138
    v_exp_f32 v139, v139
    v_smfmac_f32_32x32x32_bf16 v[48:63], v[204:207], v[120:127], v2
    v_exp_f32 v140, v140
    v_exp_f32 v141, v141
    v_exp_f32 v142, v142
    v_exp_f32 v143, v143
    v_mfma_f32_32x32x16_bf16 v[96:111], v[180:183], v[156:159], 4.0
    v_exp_f32 v80, v80
    v_exp_f32 v81, v81
    v_exp_f32 v82, v82
    v_exp_f32 v83, v83
    v_mfma_f32_32x32x16_bf16 v[96:111], v[176:179], v[152:155], v[96:111]
    v_exp_f32 v84, v84
    v_exp_f32 v85, v85
    v_exp_f32 v86, v86
    v_exp_f32 v87, v87
    v_smfmac_f32_32x32x32_bf16 v[64:79], v[200:203], v[128:135], v2
    v_exp_f32 v88, v88
    v_exp_f32 v89, v89
    v_exp_f32 v90, v90
    v_exp_f32 v91, v91
    v_smfmac_f32_32x32x32_bf16 v[64:79], v[204:207], v[136:143], v2
    v_exp_f32 v92, v92
    v_exp_f32 v93, v93
    v_exp_f32 v94, v94
    v_exp_f32 v95, v95
    ds_read_b96 v[184:186], v4 offset:34816
    ds_read_b128 v[188:191], v3 offset:34816
    ds_read_b64_tr_b16 v[200:201], v5 offset:34816
    v_mfma_f32_32x32x16_bf16 v[112:127], v[180:183], v[164:167], 4.0
    v_exp_f32 v96, v96
    v_exp_f32 v97, v97
    v_exp_f32 v98, v98
    v_exp_f32 v99, v99
    v_mfma_f32_32x32x16_bf16 v[112:127], v[176:179], v[160:163], v[112:127]
    v_exp_f32 v100, v100
    v_exp_f32 v101, v101
    v_exp_f32 v102, v102
    v_exp_f32 v103, v103
    v_smfmac_f32_32x32x32_bf16 v[16:31], v[192:195], v[80:87], v2
    v_exp_f32 v104, v104
    v_exp_f32 v105, v105
    ds_read_b64_tr_b16 v[202:203], v6 offset:34816
    ds_read_b64_tr_b16 v[206:207], v6 offset:35840
    s_setprio 2
    v_exp_f32 v106, v106
    v_exp_f32_e64 v107, v107
    v_smfmac_f32_32x32x32_bf16 v[16:31], v[196:199], v[88:95], v2
    v_exp_f32 v108, v108
    v_exp_f32 v109, v109
    v_exp_f32 v110, v110
    v_exp_f32 v111, v111
    v_mfma_f32_32x32x16_bf16 v[128:143], v[180:183], v[172:175], 4.0
    v_exp_f32 v112, v112
    v_exp_f32 v113, v113
    v_exp_f32 v114, v114
    v_exp_f32 v115, v115
    v_mfma_f32_32x32x16_bf16 v[128:143], v[176:179], v[168:171], v[128:143]
    v_exp_f32 v116, v116
    v_exp_f32 v117, v117
    v_exp_f32 v118, v118
    v_exp_f32 v119, v119
    v_smfmac_f32_32x32x32_bf16 v[32:47], v[192:195], v[96:103], v2
    v_exp_f32 v120, v120
    v_exp_f32 v121, v121
    v_exp_f32 v122, v122
    v_exp_f32 v123, v123
    v_smfmac_f32_32x32x32_bf16 v[32:47], v[196:199], v[104:111], v2
    v_exp_f32 v124, v124
    v_exp_f32 v125, v125
    ds_read_b64_tr_b16 v[204:205], v5 offset:35840
    v_exp_f32 v126, v126
    v_exp_f32 v127, v127
    s_setprio 1
    s_waitcnt lgkmcnt(1)
    v_mfma_f32_32x32x16_bf16 v[80:95], v[188:191], v[148:151], 4.0
    v_exp_f32 v128, v128
    v_exp_f32 v129, v129
    v_exp_f32 v130, v130
    v_exp_f32 v131, v131
    v_mfma_f32_32x32x16_bf16 v[80:95], v[184:187], v[144:147], v[80:95]
    v_exp_f32 v132, v132
    v_exp_f32 v133, v133
    v_exp_f32 v134, v134
    s_add_u32 m0, s35, 65792
    s_mov_b32 exec_hi, 0x00ffffff
    buffer_load_dwordx4 v8, s[16:19], s31 offen offset:1792 lds
    s_mov_b32 exec_hi, -1
    s_add_u32 s31, s31, 14336
    v_exp_f32_e64 v135, v135
    v_smfmac_f32_32x32x32_bf16 v[48:63], v[192:195], v[112:119], v2
    v_exp_f32 v136, v136
    v_exp_f32 v137, v137
    v_exp_f32 v138, v138
    v_exp_f32 v139, v139
    v_smfmac_f32_32x32x32_bf16 v[48:63], v[196:199], v[120:127], v2
    v_exp_f32 v140, v140
    v_exp_f32 v141, v141
    s_setprio 0
    v_exp_f32 v142, v142
    v_exp_f32_e64 v143, v143
    v_mfma_f32_32x32x16_bf16 v[96:111], v[188:191], v[156:159], 4.0
    v_exp_f32 v80, v80
    v_exp_f32 v81, v81
    v_exp_f32 v82, v82
    v_exp_f32 v83, v83
    v_mfma_f32_32x32x16_bf16 v[96:111], v[184:187], v[152:155], v[96:111]
    v_exp_f32 v84, v84
    s_waitcnt vmcnt(4) lgkmcnt(0)
    s_barrier
    v_exp_f32 v85, v85
    s_setprio 3
    v_exp_f32 v86, v86
    v_exp_f32_e64 v87, v87
    v_smfmac_f32_32x32x32_bf16 v[64:79], v[192:195], v[128:135], v2
    v_exp_f32 v88, v88
    v_exp_f32 v89, v89
    ds_read_b128 v[180:183], v3 offset:0
    s_add_u32 m0, s35, 32768
    s_nop 0
    buffer_load_dwordx4 v7, s[12:15], s31 offen lds
    v_exp_f32 v90, v90
    v_exp_f32_e64 v91, v91
    v_smfmac_f32_32x32x32_bf16 v[64:79], v[196:199], v[136:143], v2
    v_exp_f32 v92, v92
    v_exp_f32 v93, v93
    v_exp_f32 v94, v94
    v_exp_f32 v95, v95
    v_mfma_f32_32x32x16_bf16 v[112:127], v[188:191], v[164:167], 4.0
    v_exp_f32 v96, v96
    v_exp_f32 v97, v97
    ds_read_b96 v[176:178], v4 offset:0
    ds_read_b64_tr_b16 v[192:193], v5 offset:0
    v_exp_f32 v98, v98
    v_exp_f32 v99, v99
    v_mfma_f32_32x32x16_bf16 v[112:127], v[184:187], v[160:163], v[112:127]
    v_exp_f32 v100, v100
    v_exp_f32 v101, v101
    v_exp_f32 v102, v102
    v_exp_f32 v103, v103
    v_smfmac_f32_32x32x32_bf16 v[16:31], v[200:203], v[80:87], v2
    v_exp_f32 v104, v104
    v_exp_f32 v105, v105
    v_exp_f32 v106, v106
    v_exp_f32 v107, v107
    ds_read_b64_tr_b16 v[194:195], v6 offset:0
    ds_read_b64_tr_b16 v[196:197], v5 offset:1024
    ds_read_b64_tr_b16 v[198:199], v6 offset:1024
    v_smfmac_f32_32x32x32_bf16 v[16:31], v[204:207], v[88:95], v2
    v_exp_f32 v108, v108
    v_exp_f32 v109, v109
    v_exp_f32 v110, v110
    v_exp_f32 v111, v111
    v_mfma_f32_32x32x16_bf16 v[128:143], v[188:191], v[172:175], 4.0
    v_exp_f32 v112, v112
    v_exp_f32 v113, v113
    v_exp_f32 v114, v114
    v_exp_f32 v115, v115
    v_mfma_f32_32x32x16_bf16 v[128:143], v[184:187], v[168:171], v[128:143]
    v_exp_f32 v116, v116
    v_exp_f32 v117, v117
    v_exp_f32 v118, v118
    v_exp_f32 v119, v119
    v_smfmac_f32_32x32x32_bf16 v[32:47], v[200:203], v[96:103], v2
    v_exp_f32 v120, v120
    v_exp_f32 v121, v121
    s_add_u32 m0, s35, 81920
    s_mov_b32 exec_hi, 0x00ffffff
    buffer_load_dwordx4 v8, s[16:19], s31 offen lds
    s_mov_b32 exec_hi, -1
    v_exp_f32 v122, v122
    v_exp_f32_e64 v123, v123
    v_smfmac_f32_32x32x32_bf16 v[32:47], v[204:207], v[104:111], v2
    v_exp_f32 v124, v124
    v_exp_f32 v125, v125
    v_exp_f32 v126, v126
    v_exp_f32_e64 v127, v127
    s_waitcnt lgkmcnt(0)
    v_mfma_f32_32x32x16_bf16 v[80:95], v[180:183], v[148:151], 4.0
    v_exp_f32 v128, v128
    v_exp_f32 v129, v129
    v_exp_f32 v130, v130
    v_exp_f32 v131, v131
    v_mfma_f32_32x32x16_bf16 v[80:95], v[176:179], v[144:147], v[80:95]
    v_exp_f32 v132, v132
    v_exp_f32 v133, v133
    s_add_u32 m0, s35, 33024
    s_nop 0
    buffer_load_dwordx4 v7, s[12:15], s31 offen offset:1792 lds
    v_exp_f32 v134, v134
    v_exp_f32_e64 v135, v135
    v_smfmac_f32_32x32x32_bf16 v[48:63], v[200:203], v[112:119], v2
    v_exp_f32 v136, v136
    v_exp_f32 v137, v137
    v_exp_f32 v138, v138
    v_exp_f32 v139, v139
    v_smfmac_f32_32x32x32_bf16 v[48:63], v[204:207], v[120:127], v2
    v_exp_f32 v140, v140
    v_exp_f32 v141, v141
    v_exp_f32 v142, v142
    v_exp_f32 v143, v143
    v_mfma_f32_32x32x16_bf16 v[96:111], v[180:183], v[156:159], 4.0
    v_exp_f32 v80, v80
    v_exp_f32 v81, v81
    v_exp_f32 v82, v82
    v_exp_f32 v83, v83
    v_mfma_f32_32x32x16_bf16 v[96:111], v[176:179], v[152:155], v[96:111]
    v_exp_f32 v84, v84
    v_exp_f32 v85, v85
    v_exp_f32 v86, v86
    v_exp_f32 v87, v87
    v_smfmac_f32_32x32x32_bf16 v[64:79], v[200:203], v[128:135], v2
    v_exp_f32 v88, v88
    v_exp_f32 v89, v89
    v_exp_f32 v90, v90
    v_exp_f32 v91, v91
    v_smfmac_f32_32x32x32_bf16 v[64:79], v[204:207], v[136:143], v2
    v_exp_f32 v92, v92
    v_exp_f32 v93, v93
    v_exp_f32 v94, v94
    v_exp_f32 v95, v95
    ds_read_b96 v[184:186], v4 offset:2048
    ds_read_b128 v[188:191], v3 offset:2048
    ds_read_b64_tr_b16 v[200:201], v5 offset:2048
    v_mfma_f32_32x32x16_bf16 v[112:127], v[180:183], v[164:167], 4.0
    v_exp_f32 v96, v96
    v_exp_f32 v97, v97
    v_exp_f32 v98, v98
    v_exp_f32 v99, v99
    v_mfma_f32_32x32x16_bf16 v[112:127], v[176:179], v[160:163], v[112:127]
    v_exp_f32 v100, v100
    v_exp_f32 v101, v101
    v_exp_f32 v102, v102
    v_exp_f32 v103, v103
    v_smfmac_f32_32x32x32_bf16 v[16:31], v[192:195], v[80:87], v2
    v_exp_f32 v104, v104
    v_exp_f32 v105, v105
    ds_read_b64_tr_b16 v[202:203], v6 offset:2048
    ds_read_b64_tr_b16 v[206:207], v6 offset:3072
    s_setprio 2
    v_exp_f32 v106, v106
    v_exp_f32_e64 v107, v107
    v_smfmac_f32_32x32x32_bf16 v[16:31], v[196:199], v[88:95], v2
    v_exp_f32 v108, v108
    v_exp_f32 v109, v109
    v_exp_f32 v110, v110
    v_exp_f32 v111, v111
    v_mfma_f32_32x32x16_bf16 v[128:143], v[180:183], v[172:175], 4.0
    v_exp_f32 v112, v112
    v_exp_f32 v113, v113
    v_exp_f32 v114, v114
    v_exp_f32 v115, v115
    v_mfma_f32_32x32x16_bf16 v[128:143], v[176:179], v[168:171], v[128:143]
    v_exp_f32 v116, v116
    v_exp_f32 v117, v117
    v_exp_f32 v118, v118
    v_exp_f32 v119, v119
    v_smfmac_f32_32x32x32_bf16 v[32:47], v[192:195], v[96:103], v2
    v_exp_f32 v120, v120
    v_exp_f32 v121, v121
    v_exp_f32 v122, v122
    v_exp_f32 v123, v123
    v_smfmac_f32_32x32x32_bf16 v[32:47], v[196:199], v[104:111], v2
    v_exp_f32 v124, v124
    v_exp_f32 v125, v125
    ds_read_b64_tr_b16 v[204:205], v5 offset:3072
    v_exp_f32 v126, v126
    v_exp_f32 v127, v127
    s_setprio 1
    s_waitcnt lgkmcnt(1)
    v_mfma_f32_32x32x16_bf16 v[80:95], v[188:191], v[148:151], 4.0
    v_exp_f32 v128, v128
    v_exp_f32 v129, v129
    v_exp_f32 v130, v130
    v_exp_f32 v131, v131
    v_mfma_f32_32x32x16_bf16 v[80:95], v[184:187], v[144:147], v[80:95]
    v_exp_f32 v132, v132
    v_exp_f32 v133, v133
    v_exp_f32 v134, v134
    s_add_u32 m0, s35, 82176
    s_mov_b32 exec_hi, 0x00ffffff
    buffer_load_dwordx4 v8, s[16:19], s31 offen offset:1792 lds
    s_mov_b32 exec_hi, -1
    s_add_u32 s31, s31, 14336
    v_exp_f32_e64 v135, v135
    v_smfmac_f32_32x32x32_bf16 v[48:63], v[192:195], v[112:119], v2
    v_exp_f32 v136, v136
    v_exp_f32 v137, v137
    v_exp_f32 v138, v138
    v_exp_f32 v139, v139
    v_smfmac_f32_32x32x32_bf16 v[48:63], v[196:199], v[120:127], v2
    v_exp_f32 v140, v140
    v_exp_f32 v141, v141
    s_setprio 0
    v_exp_f32 v142, v142
    v_exp_f32_e64 v143, v143
    v_mfma_f32_32x32x16_bf16 v[96:111], v[188:191], v[156:159], 4.0
    v_exp_f32 v80, v80
    v_exp_f32 v81, v81
    v_exp_f32 v82, v82
    v_exp_f32 v83, v83
    v_mfma_f32_32x32x16_bf16 v[96:111], v[184:187], v[152:155], v[96:111]
    v_exp_f32 v84, v84
    s_waitcnt vmcnt(4) lgkmcnt(0)
    s_barrier
    v_exp_f32 v85, v85
    s_setprio 3
    v_exp_f32 v86, v86
    v_exp_f32_e64 v87, v87
    v_smfmac_f32_32x32x32_bf16 v[64:79], v[192:195], v[128:135], v2
    v_exp_f32 v88, v88
    v_exp_f32 v89, v89
    ds_read_b128 v[180:183], v3 offset:16384
    s_add_u32 m0, s35, 0
    s_nop 0
    buffer_load_dwordx4 v7, s[12:15], s31 offen lds
    v_exp_f32 v90, v90
    v_exp_f32 v91, v91
    v_smfmac_f32_32x32x32_bf16 v[64:79], v[196:199], v[136:143], v2
    v_exp_f32 v92, v92
    v_exp_f32 v93, v93
    v_exp_f32 v94, v94
    v_exp_f32 v95, v95
    v_mfma_f32_32x32x16_bf16 v[112:127], v[188:191], v[164:167], 4.0
    v_exp_f32 v96, v96
    v_exp_f32 v97, v97
    ds_read_b96 v[176:178], v4 offset:16384
    ds_read_b64_tr_b16 v[192:193], v5 offset:16384
    v_exp_f32 v98, v98
    v_exp_f32 v99, v99
    v_mfma_f32_32x32x16_bf16 v[112:127], v[184:187], v[160:163], v[112:127]
    v_exp_f32 v100, v100
    v_exp_f32 v101, v101
    v_exp_f32 v102, v102
    v_exp_f32 v103, v103
    v_smfmac_f32_32x32x32_bf16 v[16:31], v[200:203], v[80:87], v2
    v_exp_f32 v104, v104
    v_exp_f32 v105, v105
    v_exp_f32 v106, v106
    v_exp_f32 v107, v107
    ds_read_b64_tr_b16 v[194:195], v6 offset:16384
    ds_read_b64_tr_b16 v[196:197], v5 offset:17408
    ds_read_b64_tr_b16 v[198:199], v6 offset:17408
    v_smfmac_f32_32x32x32_bf16 v[16:31], v[204:207], v[88:95], v2
    v_exp_f32 v108, v108
    v_exp_f32 v109, v109
    v_exp_f32 v110, v110
    v_exp_f32 v111, v111
    v_mfma_f32_32x32x16_bf16 v[128:143], v[188:191], v[172:175], 4.0
    v_exp_f32 v112, v112
    v_exp_f32 v113, v113
    v_exp_f32 v114, v114
    v_exp_f32 v115, v115
    v_mfma_f32_32x32x16_bf16 v[128:143], v[184:187], v[168:171], v[128:143]
    v_exp_f32 v116, v116
    v_exp_f32 v117, v117
    v_exp_f32 v118, v118
    v_exp_f32 v119, v119
    v_smfmac_f32_32x32x32_bf16 v[32:47], v[200:203], v[96:103], v2
    v_exp_f32 v120, v120
    v_exp_f32 v121, v121
    s_add_u32 m0, s35, 49152
    s_mov_b32 exec_hi, 0x00ffffff
    buffer_load_dwordx4 v8, s[16:19], s31 offen lds
    s_mov_b32 exec_hi, -1
    v_exp_f32 v122, v122
    v_exp_f32_e64 v123, v123
    v_smfmac_f32_32x32x32_bf16 v[32:47], v[204:207], v[104:111], v2
    v_exp_f32 v124, v124
    v_exp_f32 v125, v125
    v_exp_f32 v126, v126
    v_exp_f32_e64 v127, v127
    s_waitcnt lgkmcnt(0)
    v_mfma_f32_32x32x16_bf16 v[80:95], v[180:183], v[148:151], 4.0
    v_exp_f32 v128, v128
    v_exp_f32 v129, v129
    v_exp_f32 v130, v130
    v_exp_f32 v131, v131
    v_mfma_f32_32x32x16_bf16 v[80:95], v[176:179], v[144:147], v[80:95]
    v_exp_f32 v132, v132
    v_exp_f32 v133, v133
    s_add_u32 m0, s35, 256
    s_nop 0
    buffer_load_dwordx4 v7, s[12:15], s31 offen offset:1792 lds
    v_exp_f32 v134, v134
    v_exp_f32_e64 v135, v135
    v_smfmac_f32_32x32x32_bf16 v[48:63], v[200:203], v[112:119], v2
    v_exp_f32 v136, v136
    v_exp_f32 v137, v137
    v_exp_f32 v138, v138
    v_exp_f32 v139, v139
    v_smfmac_f32_32x32x32_bf16 v[48:63], v[204:207], v[120:127], v2
    v_exp_f32 v140, v140
    v_exp_f32 v141, v141
    v_exp_f32 v142, v142
    v_exp_f32 v143, v143
    v_mfma_f32_32x32x16_bf16 v[96:111], v[180:183], v[156:159], 4.0
    v_exp_f32 v80, v80
    v_exp_f32 v81, v81
    v_exp_f32 v82, v82
    v_exp_f32 v83, v83
    v_mfma_f32_32x32x16_bf16 v[96:111], v[176:179], v[152:155], v[96:111]
    v_exp_f32 v84, v84
    v_exp_f32 v85, v85
    v_exp_f32 v86, v86
    v_exp_f32 v87, v87
    v_smfmac_f32_32x32x32_bf16 v[64:79], v[200:203], v[128:135], v2
    v_exp_f32 v88, v88
    v_exp_f32 v89, v89
    v_exp_f32 v90, v90
    v_exp_f32 v91, v91
    v_smfmac_f32_32x32x32_bf16 v[64:79], v[204:207], v[136:143], v2
    v_exp_f32 v92, v92
    v_exp_f32 v93, v93
    v_exp_f32 v94, v94
    v_exp_f32 v95, v95
    ds_read_b96 v[184:186], v4 offset:18432
    ds_read_b128 v[188:191], v3 offset:18432
    ds_read_b64_tr_b16 v[200:201], v5 offset:18432
    v_mfma_f32_32x32x16_bf16 v[112:127], v[180:183], v[164:167], 4.0
    v_exp_f32 v96, v96
    v_exp_f32 v97, v97
    v_exp_f32 v98, v98
    v_exp_f32 v99, v99
    v_mfma_f32_32x32x16_bf16 v[112:127], v[176:179], v[160:163], v[112:127]
    v_exp_f32 v100, v100
    v_exp_f32 v101, v101
    v_exp_f32 v102, v102
    v_exp_f32 v103, v103
    v_smfmac_f32_32x32x32_bf16 v[16:31], v[192:195], v[80:87], v2
    v_exp_f32 v104, v104
    v_exp_f32 v105, v105
    ds_read_b64_tr_b16 v[202:203], v6 offset:18432
    ds_read_b64_tr_b16 v[206:207], v6 offset:19456
    s_setprio 2
    v_exp_f32 v106, v106
    v_exp_f32_e64 v107, v107
    v_smfmac_f32_32x32x32_bf16 v[16:31], v[196:199], v[88:95], v2
    v_exp_f32 v108, v108
    v_exp_f32 v109, v109
    v_exp_f32 v110, v110
    v_exp_f32 v111, v111
    v_mfma_f32_32x32x16_bf16 v[128:143], v[180:183], v[172:175], 4.0
    v_exp_f32 v112, v112
    v_exp_f32 v113, v113
    v_exp_f32 v114, v114
    v_exp_f32 v115, v115
    v_mfma_f32_32x32x16_bf16 v[128:143], v[176:179], v[168:171], v[128:143]
    v_exp_f32 v116, v116
    v_exp_f32 v117, v117
    v_exp_f32 v118, v118
    v_exp_f32 v119, v119
    v_smfmac_f32_32x32x32_bf16 v[32:47], v[192:195], v[96:103], v2
    v_exp_f32 v120, v120
    v_exp_f32 v121, v121
    v_exp_f32 v122, v122
    v_exp_f32 v123, v123
    v_smfmac_f32_32x32x32_bf16 v[32:47], v[196:199], v[104:111], v2
    v_exp_f32 v124, v124
    v_exp_f32 v125, v125
    ds_read_b64_tr_b16 v[204:205], v5 offset:19456
    v_exp_f32 v126, v126
    v_exp_f32 v127, v127
    s_setprio 1
    s_waitcnt lgkmcnt(1)
    v_mfma_f32_32x32x16_bf16 v[80:95], v[188:191], v[148:151], 4.0
    v_exp_f32 v128, v128
    v_exp_f32 v129, v129
    v_exp_f32 v130, v130
    v_exp_f32 v131, v131
    v_mfma_f32_32x32x16_bf16 v[80:95], v[184:187], v[144:147], v[80:95]
    v_exp_f32 v132, v132
    v_exp_f32 v133, v133
    v_exp_f32 v134, v134
    s_add_u32 m0, s35, 49408
    s_mov_b32 exec_hi, 0x00ffffff
    buffer_load_dwordx4 v8, s[16:19], s31 offen offset:1792 lds
    s_mov_b32 exec_hi, -1
    s_add_u32 s31, s31, 14336
    v_exp_f32_e64 v135, v135
    v_smfmac_f32_32x32x32_bf16 v[48:63], v[192:195], v[112:119], v2
    v_exp_f32 v136, v136
    v_exp_f32 v137, v137
    v_exp_f32 v138, v138
    v_exp_f32 v139, v139
    v_smfmac_f32_32x32x32_bf16 v[48:63], v[196:199], v[120:127], v2
    v_exp_f32 v140, v140
    v_exp_f32 v141, v141
    s_setprio 0
    v_exp_f32 v142, v142
    v_exp_f32_e64 v143, v143
    v_mfma_f32_32x32x16_bf16 v[96:111], v[188:191], v[156:159], 4.0
    v_exp_f32 v80, v80
    v_exp_f32 v81, v81
    v_exp_f32 v82, v82
    v_exp_f32 v83, v83
    v_mfma_f32_32x32x16_bf16 v[96:111], v[184:187], v[152:155], v[96:111]
    v_exp_f32 v84, v84
    s_waitcnt vmcnt(4) lgkmcnt(0)
    s_barrier
    v_exp_f32 v85, v85
    s_setprio 3
    v_exp_f32 v86, v86
    v_exp_f32_e64 v87, v87
    v_smfmac_f32_32x32x32_bf16 v[64:79], v[192:195], v[128:135], v2
    v_exp_f32 v88, v88
    v_exp_f32 v89, v89
    ds_read_b128 v[180:183], v3 offset:32768
    s_add_u32 m0, s35, 16384
    s_nop 0
    buffer_load_dwordx4 v7, s[12:15], s31 offen lds
    v_exp_f32 v90, v90
    v_exp_f32_e64 v91, v91
    v_smfmac_f32_32x32x32_bf16 v[64:79], v[196:199], v[136:143], v2
    v_exp_f32 v92, v92
    v_exp_f32 v93, v93
    v_exp_f32 v94, v94
    v_exp_f32 v95, v95
    v_mfma_f32_32x32x16_bf16 v[112:127], v[188:191], v[164:167], 4.0
    v_exp_f32 v96, v96
    v_exp_f32 v97, v97
    ds_read_b96 v[176:178], v4 offset:32768
    ds_read_b64_tr_b16 v[192:193], v5 offset:32768
    v_exp_f32 v98, v98
    v_exp_f32 v99, v99
    v_mfma_f32_32x32x16_bf16 v[112:127], v[184:187], v[160:163], v[112:127]
    v_exp_f32 v100, v100
    v_exp_f32 v101, v101
    v_exp_f32 v102, v102
    v_exp_f32 v103, v103
    v_smfmac_f32_32x32x32_bf16 v[16:31], v[200:203], v[80:87], v2
    v_exp_f32 v104, v104
    v_exp_f32 v105, v105
    v_exp_f32 v106, v106
    v_exp_f32 v107, v107
    ds_read_b64_tr_b16 v[194:195], v6 offset:32768
    ds_read_b64_tr_b16 v[196:197], v5 offset:33792
    ds_read_b64_tr_b16 v[198:199], v6 offset:33792
    v_smfmac_f32_32x32x32_bf16 v[16:31], v[204:207], v[88:95], v2
    v_exp_f32 v108, v108
    v_exp_f32 v109, v109
    v_exp_f32 v110, v110
    v_exp_f32 v111, v111
    v_mfma_f32_32x32x16_bf16 v[128:143], v[188:191], v[172:175], 4.0
    v_exp_f32 v112, v112
    v_exp_f32 v113, v113
    v_exp_f32 v114, v114
    v_exp_f32 v115, v115
    v_mfma_f32_32x32x16_bf16 v[128:143], v[184:187], v[168:171], v[128:143]
    v_exp_f32 v116, v116
    v_exp_f32 v117, v117
    v_exp_f32 v118, v118
    v_exp_f32 v119, v119
    v_smfmac_f32_32x32x32_bf16 v[32:47], v[200:203], v[96:103], v2
    v_exp_f32 v120, v120
    v_exp_f32 v121, v121
    s_add_u32 m0, s35, 65536
    s_mov_b32 exec_hi, 0x00ffffff
    buffer_load_dwordx4 v8, s[16:19], s31 offen lds
    s_mov_b32 exec_hi, -1
    v_exp_f32 v122, v122
    v_exp_f32_e64 v123, v123
    v_smfmac_f32_32x32x32_bf16 v[32:47], v[204:207], v[104:111], v2
    v_exp_f32 v124, v124
    v_exp_f32 v125, v125
    v_exp_f32 v126, v126
    v_exp_f32_e64 v127, v127
    s_waitcnt lgkmcnt(0)
    v_mfma_f32_32x32x16_bf16 v[80:95], v[180:183], v[148:151], 4.0
    v_exp_f32 v128, v128
    v_exp_f32 v129, v129
    v_exp_f32 v130, v130
    v_exp_f32 v131, v131
    v_mfma_f32_32x32x16_bf16 v[80:95], v[176:179], v[144:147], v[80:95]
    v_exp_f32 v132, v132
    v_exp_f32 v133, v133
    s_add_u32 m0, s35, 16640
    s_nop 0
    buffer_load_dwordx4 v7, s[12:15], s31 offen offset:1792 lds
    v_exp_f32 v134, v134
    v_exp_f32_e64 v135, v135
    v_smfmac_f32_32x32x32_bf16 v[48:63], v[200:203], v[112:119], v2
    v_exp_f32 v136, v136
    v_exp_f32 v137, v137
    v_exp_f32 v138, v138
    v_exp_f32 v139, v139
    v_smfmac_f32_32x32x32_bf16 v[48:63], v[204:207], v[120:127], v2
    v_exp_f32 v140, v140
    v_exp_f32 v141, v141
    v_exp_f32 v142, v142
    v_exp_f32 v143, v143
    v_mfma_f32_32x32x16_bf16 v[96:111], v[180:183], v[156:159], 4.0
    v_exp_f32 v80, v80
    v_exp_f32 v81, v81
    v_exp_f32 v82, v82
    v_exp_f32 v83, v83
    v_mfma_f32_32x32x16_bf16 v[96:111], v[176:179], v[152:155], v[96:111]
    v_exp_f32 v84, v84
    v_exp_f32 v85, v85
    v_exp_f32 v86, v86
    v_exp_f32 v87, v87
    v_smfmac_f32_32x32x32_bf16 v[64:79], v[200:203], v[128:135], v2
    v_exp_f32 v88, v88
    v_exp_f32 v89, v89
    v_exp_f32 v90, v90
    v_exp_f32 v91, v91
    v_smfmac_f32_32x32x32_bf16 v[64:79], v[204:207], v[136:143], v2
    v_exp_f32 v92, v92
    v_exp_f32 v93, v93
    v_exp_f32 v94, v94
    v_exp_f32 v95, v95
    ds_read_b96 v[184:186], v4 offset:34816
    ds_read_b128 v[188:191], v3 offset:34816
    ds_read_b64_tr_b16 v[200:201], v5 offset:34816
    v_mfma_f32_32x32x16_bf16 v[112:127], v[180:183], v[164:167], 4.0
    v_exp_f32 v96, v96
    v_exp_f32 v97, v97
    v_exp_f32 v98, v98
    v_exp_f32 v99, v99
    v_mfma_f32_32x32x16_bf16 v[112:127], v[176:179], v[160:163], v[112:127]
    v_exp_f32 v100, v100
    v_exp_f32 v101, v101
    v_exp_f32 v102, v102
    v_exp_f32 v103, v103
    v_smfmac_f32_32x32x32_bf16 v[16:31], v[192:195], v[80:87], v2
    v_exp_f32 v104, v104
    v_exp_f32 v105, v105
    ds_read_b64_tr_b16 v[202:203], v6 offset:34816
    ds_read_b64_tr_b16 v[206:207], v6 offset:35840
    s_setprio 2
    v_exp_f32 v106, v106
    v_exp_f32_e64 v107, v107
    v_smfmac_f32_32x32x32_bf16 v[16:31], v[196:199], v[88:95], v2
    v_exp_f32 v108, v108
    v_exp_f32 v109, v109
    v_exp_f32 v110, v110
    v_exp_f32 v111, v111
    v_mfma_f32_32x32x16_bf16 v[128:143], v[180:183], v[172:175], 4.0
    v_exp_f32 v112, v112
    v_exp_f32 v113, v113
    v_exp_f32 v114, v114
    v_exp_f32 v115, v115
    v_mfma_f32_32x32x16_bf16 v[128:143], v[176:179], v[168:171], v[128:143]
    v_exp_f32 v116, v116
    v_exp_f32 v117, v117
    v_exp_f32 v118, v118
    v_exp_f32 v119, v119
    v_smfmac_f32_32x32x32_bf16 v[32:47], v[192:195], v[96:103], v2
    v_exp_f32 v120, v120
    v_exp_f32 v121, v121
    v_exp_f32 v122, v122
    v_exp_f32 v123, v123
    v_smfmac_f32_32x32x32_bf16 v[32:47], v[196:199], v[104:111], v2
    v_exp_f32 v124, v124
    v_exp_f32 v125, v125
    ds_read_b64_tr_b16 v[204:205], v5 offset:35840
    v_exp_f32 v126, v126
    v_exp_f32 v127, v127
    s_setprio 1
    s_waitcnt lgkmcnt(1)
    v_mfma_f32_32x32x16_bf16 v[80:95], v[188:191], v[148:151], 4.0
    v_exp_f32 v128, v128
    v_exp_f32 v129, v129
    v_exp_f32 v130, v130
    v_exp_f32 v131, v131
    v_mfma_f32_32x32x16_bf16 v[80:95], v[184:187], v[144:147], v[80:95]
    v_exp_f32 v132, v132
    v_exp_f32 v133, v133
    v_exp_f32 v134, v134
    s_add_u32 m0, s35, 65792
    s_mov_b32 exec_hi, 0x00ffffff
    buffer_load_dwordx4 v8, s[16:19], s31 offen offset:1792 lds
    s_mov_b32 exec_hi, -1
    s_add_u32 s31, s31, 14336
    v_exp_f32_e64 v135, v135
    v_smfmac_f32_32x32x32_bf16 v[48:63], v[192:195], v[112:119], v2
    v_exp_f32 v136, v136
    v_exp_f32 v137, v137
    v_exp_f32 v138, v138
    v_exp_f32 v139, v139
    v_smfmac_f32_32x32x32_bf16 v[48:63], v[196:199], v[120:127], v2
    v_exp_f32 v140, v140
    v_exp_f32 v141, v141
    s_setprio 0
    v_exp_f32 v142, v142
    v_exp_f32_e64 v143, v143
    v_mfma_f32_32x32x16_bf16 v[96:111], v[188:191], v[156:159], 4.0
    v_exp_f32 v80, v80
    v_exp_f32 v81, v81
    v_exp_f32 v82, v82
    v_exp_f32 v83, v83
    v_mfma_f32_32x32x16_bf16 v[96:111], v[184:187], v[152:155], v[96:111]
    v_exp_f32 v84, v84
    s_waitcnt vmcnt(4) lgkmcnt(0)
    s_barrier
    v_exp_f32 v85, v85
    s_setprio 3
    v_exp_f32 v86, v86
    v_exp_f32_e64 v87, v87
    v_smfmac_f32_32x32x32_bf16 v[64:79], v[192:195], v[128:135], v2
    v_exp_f32 v88, v88
    v_exp_f32 v89, v89
    ds_read_b128 v[180:183], v3 offset:0
    s_add_u32 m0, s35, 32768
    s_nop 0
    buffer_load_dwordx4 v7, s[12:15], s31 offen lds
    v_exp_f32 v90, v90
    v_exp_f32_e64 v91, v91
    v_smfmac_f32_32x32x32_bf16 v[64:79], v[196:199], v[136:143], v2
    v_exp_f32 v92, v92
    v_exp_f32 v93, v93
    v_exp_f32 v94, v94
    v_exp_f32 v95, v95
    v_mfma_f32_32x32x16_bf16 v[112:127], v[188:191], v[164:167], 4.0
    v_exp_f32 v96, v96
    v_exp_f32 v97, v97
    ds_read_b96 v[176:178], v4 offset:0
    ds_read_b64_tr_b16 v[192:193], v5 offset:0
    v_exp_f32 v98, v98
    v_exp_f32 v99, v99
    v_mfma_f32_32x32x16_bf16 v[112:127], v[184:187], v[160:163], v[112:127]
    v_exp_f32 v100, v100
    v_exp_f32 v101, v101
    v_exp_f32 v102, v102
    v_exp_f32 v103, v103
    v_smfmac_f32_32x32x32_bf16 v[16:31], v[200:203], v[80:87], v2
    v_exp_f32 v104, v104
    v_exp_f32 v105, v105
    v_exp_f32 v106, v106
    v_exp_f32 v107, v107
    ds_read_b64_tr_b16 v[194:195], v6 offset:0
    ds_read_b64_tr_b16 v[196:197], v5 offset:1024
    ds_read_b64_tr_b16 v[198:199], v6 offset:1024
    v_smfmac_f32_32x32x32_bf16 v[16:31], v[204:207], v[88:95], v2
    v_exp_f32 v108, v108
    v_exp_f32 v109, v109
    v_exp_f32 v110, v110
    v_exp_f32 v111, v111
    v_mfma_f32_32x32x16_bf16 v[128:143], v[188:191], v[172:175], 4.0
    v_exp_f32 v112, v112
    v_exp_f32 v113, v113
    v_exp_f32 v114, v114
    v_exp_f32 v115, v115
    v_mfma_f32_32x32x16_bf16 v[128:143], v[184:187], v[168:171], v[128:143]
    v_exp_f32 v116, v116
    v_exp_f32 v117, v117
    v_exp_f32 v118, v118
    v_exp_f32 v119, v119
    v_smfmac_f32_32x32x32_bf16 v[32:47], v[200:203], v[96:103], v2
    v_exp_f32 v120, v120
    v_exp_f32 v121, v121
    s_add_u32 m0, s35, 81920
    s_mov_b32 exec_hi, 0x00ffffff
    buffer_load_dwordx4 v8, s[16:19], s31 offen lds
    s_mov_b32 exec_hi, -1
    v_exp_f32 v122, v122
    v_exp_f32_e64 v123, v123
    v_smfmac_f32_32x32x32_bf16 v[32:47], v[204:207], v[104:111], v2
    v_exp_f32 v124, v124
    v_exp_f32 v125, v125
    v_exp_f32 v126, v126
    v_exp_f32_e64 v127, v127
    s_waitcnt lgkmcnt(0)
    v_mfma_f32_32x32x16_bf16 v[80:95], v[180:183], v[148:151], 4.0
    v_exp_f32 v128, v128
    v_exp_f32 v129, v129
    v_exp_f32 v130, v130
    v_exp_f32 v131, v131
    v_mfma_f32_32x32x16_bf16 v[80:95], v[176:179], v[144:147], v[80:95]
    v_exp_f32 v132, v132
    v_exp_f32 v133, v133
    s_add_u32 m0, s35, 33024
    s_nop 0
    buffer_load_dwordx4 v7, s[12:15], s31 offen offset:1792 lds
    v_exp_f32 v134, v134
    v_exp_f32_e64 v135, v135
    v_smfmac_f32_32x32x32_bf16 v[48:63], v[200:203], v[112:119], v2
    v_exp_f32 v136, v136
    v_exp_f32 v137, v137
    v_exp_f32 v138, v138
    v_exp_f32 v139, v139
    v_smfmac_f32_32x32x32_bf16 v[48:63], v[204:207], v[120:127], v2
    v_exp_f32 v140, v140
    v_exp_f32 v141, v141
    v_exp_f32 v142, v142
    v_exp_f32 v143, v143
    v_mfma_f32_32x32x16_bf16 v[96:111], v[180:183], v[156:159], 4.0
    v_exp_f32 v80, v80
    v_exp_f32 v81, v81
    v_exp_f32 v82, v82
    v_exp_f32 v83, v83
    v_mfma_f32_32x32x16_bf16 v[96:111], v[176:179], v[152:155], v[96:111]
    v_exp_f32 v84, v84
    v_exp_f32 v85, v85
    v_exp_f32 v86, v86
    v_exp_f32 v87, v87
    v_smfmac_f32_32x32x32_bf16 v[64:79], v[200:203], v[128:135], v2
    v_exp_f32 v88, v88
    v_exp_f32 v89, v89
    v_exp_f32 v90, v90
    v_exp_f32 v91, v91
    v_smfmac_f32_32x32x32_bf16 v[64:79], v[204:207], v[136:143], v2
    v_exp_f32 v92, v92
    v_exp_f32 v93, v93
    v_exp_f32 v94, v94
    v_exp_f32 v95, v95
    ds_read_b96 v[184:186], v4 offset:2048
    ds_read_b128 v[188:191], v3 offset:2048
    ds_read_b64_tr_b16 v[200:201], v5 offset:2048
    v_mfma_f32_32x32x16_bf16 v[112:127], v[180:183], v[164:167], 4.0
    v_exp_f32 v96, v96
    v_exp_f32 v97, v97
    v_exp_f32 v98, v98
    v_exp_f32 v99, v99
    v_mfma_f32_32x32x16_bf16 v[112:127], v[176:179], v[160:163], v[112:127]
    v_exp_f32 v100, v100
    v_exp_f32 v101, v101
    v_exp_f32 v102, v102
    v_exp_f32 v103, v103
    v_smfmac_f32_32x32x32_bf16 v[16:31], v[192:195], v[80:87], v2
    v_exp_f32 v104, v104
    v_exp_f32 v105, v105
    ds_read_b64_tr_b16 v[202:203], v6 offset:2048
    ds_read_b64_tr_b16 v[206:207], v6 offset:3072
    s_setprio 2
    v_exp_f32 v106, v106
    v_exp_f32_e64 v107, v107
    v_smfmac_f32_32x32x32_bf16 v[16:31], v[196:199], v[88:95], v2
    v_exp_f32 v108, v108
    v_exp_f32 v109, v109
    v_exp_f32 v110, v110
    v_exp_f32 v111, v111
    v_mfma_f32_32x32x16_bf16 v[128:143], v[180:183], v[172:175], 4.0
    v_exp_f32 v112, v112
    v_exp_f32 v113, v113
    v_exp_f32 v114, v114
    v_exp_f32 v115, v115
    v_mfma_f32_32x32x16_bf16 v[128:143], v[176:179], v[168:171], v[128:143]
    v_exp_f32 v116, v116
    v_exp_f32 v117, v117
    v_exp_f32 v118, v118
    v_exp_f32 v119, v119
    v_smfmac_f32_32x32x32_bf16 v[32:47], v[192:195], v[96:103], v2
    v_exp_f32 v120, v120
    v_exp_f32 v121, v121
    v_exp_f32 v122, v122
    v_exp_f32 v123, v123
    v_smfmac_f32_32x32x32_bf16 v[32:47], v[196:199], v[104:111], v2
    v_exp_f32 v124, v124
    v_exp_f32 v125, v125
    ds_read_b64_tr_b16 v[204:205], v5 offset:3072
    v_exp_f32 v126, v126
    v_exp_f32 v127, v127
    s_setprio 1
    s_waitcnt lgkmcnt(1)
    v_mfma_f32_32x32x16_bf16 v[80:95], v[188:191], v[148:151], 4.0
    v_exp_f32 v128, v128
    v_exp_f32 v129, v129
    v_exp_f32 v130, v130
    v_exp_f32 v131, v131
    v_mfma_f32_32x32x16_bf16 v[80:95], v[184:187], v[144:147], v[80:95]
    v_exp_f32 v132, v132
    v_exp_f32 v133, v133
    v_exp_f32 v134, v134
    s_add_u32 m0, s35, 82176
    s_mov_b32 exec_hi, 0x00ffffff
    buffer_load_dwordx4 v8, s[16:19], s31 offen offset:1792 lds
    s_mov_b32 exec_hi, -1
    s_add_u32 s31, s31, 14336
    v_exp_f32_e64 v135, v135
    v_smfmac_f32_32x32x32_bf16 v[48:63], v[192:195], v[112:119], v2
    v_exp_f32 v136, v136
    v_exp_f32 v137, v137
    v_exp_f32 v138, v138
    v_exp_f32 v139, v139
    v_smfmac_f32_32x32x32_bf16 v[48:63], v[196:199], v[120:127], v2
    v_exp_f32 v140, v140
    v_exp_f32 v141, v141
    s_setprio 0
    v_exp_f32 v142, v142
    v_exp_f32_e64 v143, v143
    v_mfma_f32_32x32x16_bf16 v[96:111], v[188:191], v[156:159], 4.0
    v_exp_f32 v80, v80
    v_exp_f32 v81, v81
    v_exp_f32 v82, v82
    v_exp_f32 v83, v83
    v_mfma_f32_32x32x16_bf16 v[96:111], v[184:187], v[152:155], v[96:111]
    v_exp_f32 v84, v84
    s_waitcnt vmcnt(4) lgkmcnt(0)
    s_barrier
    v_exp_f32 v85, v85
    s_setprio 3
    v_exp_f32 v86, v86
    v_exp_f32_e64 v87, v87
    v_smfmac_f32_32x32x32_bf16 v[64:79], v[192:195], v[128:135], v2
    v_exp_f32 v88, v88
    v_exp_f32 v89, v89
    ds_read_b128 v[180:183], v3 offset:16384
    s_add_u32 m0, s35, 0
    s_nop 0
    buffer_load_dwordx4 v7, s[12:15], s31 offen lds
    v_exp_f32 v90, v90
    v_exp_f32 v91, v91
    v_smfmac_f32_32x32x32_bf16 v[64:79], v[196:199], v[136:143], v2
    v_exp_f32 v92, v92
    v_exp_f32 v93, v93
    v_exp_f32 v94, v94
    v_exp_f32 v95, v95
    v_mfma_f32_32x32x16_bf16 v[112:127], v[188:191], v[164:167], 4.0
    v_exp_f32 v96, v96
    v_exp_f32 v97, v97
    ds_read_b96 v[176:178], v4 offset:16384
    ds_read_b64_tr_b16 v[192:193], v5 offset:16384
    v_exp_f32 v98, v98
    v_exp_f32 v99, v99
    v_mfma_f32_32x32x16_bf16 v[112:127], v[184:187], v[160:163], v[112:127]
    v_exp_f32 v100, v100
    v_exp_f32 v101, v101
    v_exp_f32 v102, v102
    v_exp_f32 v103, v103
    v_smfmac_f32_32x32x32_bf16 v[16:31], v[200:203], v[80:87], v2
    v_exp_f32 v104, v104
    v_exp_f32 v105, v105
    v_exp_f32 v106, v106
    v_exp_f32 v107, v107
    ds_read_b64_tr_b16 v[194:195], v6 offset:16384
    ds_read_b64_tr_b16 v[196:197], v5 offset:17408
    ds_read_b64_tr_b16 v[198:199], v6 offset:17408
    v_smfmac_f32_32x32x32_bf16 v[16:31], v[204:207], v[88:95], v2
    v_exp_f32 v108, v108
    v_exp_f32 v109, v109
    v_exp_f32 v110, v110
    v_exp_f32 v111, v111
    v_mfma_f32_32x32x16_bf16 v[128:143], v[188:191], v[172:175], 4.0
    v_exp_f32 v112, v112
    v_exp_f32 v113, v113
    v_exp_f32 v114, v114
    v_exp_f32 v115, v115
    v_mfma_f32_32x32x16_bf16 v[128:143], v[184:187], v[168:171], v[128:143]
    v_exp_f32 v116, v116
    v_exp_f32 v117, v117
    v_exp_f32 v118, v118
    v_exp_f32 v119, v119
    v_smfmac_f32_32x32x32_bf16 v[32:47], v[200:203], v[96:103], v2
    v_exp_f32 v120, v120
    v_exp_f32 v121, v121
    s_add_u32 m0, s35, 49152
    s_mov_b32 exec_hi, 0x00ffffff
    buffer_load_dwordx4 v8, s[16:19], s31 offen lds
    s_mov_b32 exec_hi, -1
    v_exp_f32 v122, v122
    v_exp_f32_e64 v123, v123
    v_smfmac_f32_32x32x32_bf16 v[32:47], v[204:207], v[104:111], v2
    v_exp_f32 v124, v124
    v_exp_f32 v125, v125
    v_exp_f32 v126, v126
    v_exp_f32_e64 v127, v127
    s_waitcnt lgkmcnt(0)
    v_mfma_f32_32x32x16_bf16 v[80:95], v[180:183], v[148:151], 4.0
    v_exp_f32 v128, v128
    v_exp_f32 v129, v129
    v_exp_f32 v130, v130
    v_exp_f32 v131, v131
    v_mfma_f32_32x32x16_bf16 v[80:95], v[176:179], v[144:147], v[80:95]
    v_exp_f32 v132, v132
    v_exp_f32 v133, v133
    s_add_u32 m0, s35, 256
    s_nop 0
    buffer_load_dwordx4 v7, s[12:15], s31 offen offset:1792 lds
    v_exp_f32 v134, v134
    v_exp_f32_e64 v135, v135
    v_smfmac_f32_32x32x32_bf16 v[48:63], v[200:203], v[112:119], v2
    v_exp_f32 v136, v136
    v_exp_f32 v137, v137
    v_exp_f32 v138, v138
    v_exp_f32 v139, v139
    v_smfmac_f32_32x32x32_bf16 v[48:63], v[204:207], v[120:127], v2
    v_exp_f32 v140, v140
    v_exp_f32 v141, v141
    v_exp_f32 v142, v142
    v_exp_f32 v143, v143
    v_mfma_f32_32x32x16_bf16 v[96:111], v[180:183], v[156:159], 4.0
    v_exp_f32 v80, v80
    v_exp_f32 v81, v81
    v_exp_f32 v82, v82
    v_exp_f32 v83, v83
    v_mfma_f32_32x32x16_bf16 v[96:111], v[176:179], v[152:155], v[96:111]
    v_exp_f32 v84, v84
    v_exp_f32 v85, v85
    v_exp_f32 v86, v86
    v_exp_f32 v87, v87
    v_smfmac_f32_32x32x32_bf16 v[64:79], v[200:203], v[128:135], v2
    v_exp_f32 v88, v88
    v_exp_f32 v89, v89
    v_exp_f32 v90, v90
    v_exp_f32 v91, v91
    v_smfmac_f32_32x32x32_bf16 v[64:79], v[204:207], v[136:143], v2
    v_exp_f32 v92, v92
    v_exp_f32 v93, v93
    v_exp_f32 v94, v94
    v_exp_f32 v95, v95
    ds_read_b96 v[184:186], v4 offset:18432
    ds_read_b128 v[188:191], v3 offset:18432
    ds_read_b64_tr_b16 v[200:201], v5 offset:18432
    v_mfma_f32_32x32x16_bf16 v[112:127], v[180:183], v[164:167], 4.0
    v_exp_f32 v96, v96
    v_exp_f32 v97, v97
    v_exp_f32 v98, v98
    v_exp_f32 v99, v99
    v_mfma_f32_32x32x16_bf16 v[112:127], v[176:179], v[160:163], v[112:127]
    v_exp_f32 v100, v100
    v_exp_f32 v101, v101
    v_exp_f32 v102, v102
    v_exp_f32 v103, v103
    v_smfmac_f32_32x32x32_bf16 v[16:31], v[192:195], v[80:87], v2
    v_exp_f32 v104, v104
    v_exp_f32 v105, v105
    ds_read_b64_tr_b16 v[202:203], v6 offset:18432
    ds_read_b64_tr_b16 v[206:207], v6 offset:19456
    s_setprio 2
    v_exp_f32 v106, v106
    v_exp_f32_e64 v107, v107
    v_smfmac_f32_32x32x32_bf16 v[16:31], v[196:199], v[88:95], v2
    v_exp_f32 v108, v108
    v_exp_f32 v109, v109
    v_exp_f32 v110, v110
    v_exp_f32 v111, v111
    v_mfma_f32_32x32x16_bf16 v[128:143], v[180:183], v[172:175], 4.0
    v_exp_f32 v112, v112
    v_exp_f32 v113, v113
    v_exp_f32 v114, v114
    v_exp_f32 v115, v115
    v_mfma_f32_32x32x16_bf16 v[128:143], v[176:179], v[168:171], v[128:143]
    v_exp_f32 v116, v116
    v_exp_f32 v117, v117
    v_exp_f32 v118, v118
    v_exp_f32 v119, v119
    v_smfmac_f32_32x32x32_bf16 v[32:47], v[192:195], v[96:103], v2
    v_exp_f32 v120, v120
    v_exp_f32 v121, v121
    v_exp_f32 v122, v122
    v_exp_f32 v123, v123
    v_smfmac_f32_32x32x32_bf16 v[32:47], v[196:199], v[104:111], v2
    v_exp_f32 v124, v124
    v_exp_f32 v125, v125
    ds_read_b64_tr_b16 v[204:205], v5 offset:19456
    v_exp_f32 v126, v126
    v_exp_f32 v127, v127
    s_setprio 1
    s_waitcnt lgkmcnt(1)
    v_mfma_f32_32x32x16_bf16 v[80:95], v[188:191], v[148:151], 4.0
    v_exp_f32 v128, v128
    v_exp_f32 v129, v129
    v_exp_f32 v130, v130
    v_exp_f32 v131, v131
    v_mfma_f32_32x32x16_bf16 v[80:95], v[184:187], v[144:147], v[80:95]
    v_exp_f32 v132, v132
    v_exp_f32 v133, v133
    v_exp_f32 v134, v134
    s_add_u32 m0, s35, 49408
    s_mov_b32 exec_hi, 0x00ffffff
    buffer_load_dwordx4 v8, s[16:19], s31 offen offset:1792 lds
    s_mov_b32 exec_hi, -1
    s_add_u32 s31, s31, 14336
    v_exp_f32_e64 v135, v135
    v_smfmac_f32_32x32x32_bf16 v[48:63], v[192:195], v[112:119], v2
    v_exp_f32 v136, v136
    v_exp_f32 v137, v137
    v_exp_f32 v138, v138
    v_exp_f32 v139, v139
    v_smfmac_f32_32x32x32_bf16 v[48:63], v[196:199], v[120:127], v2
    v_exp_f32 v140, v140
    v_exp_f32 v141, v141
    s_setprio 0
    v_exp_f32 v142, v142
    v_exp_f32_e64 v143, v143
    v_mfma_f32_32x32x16_bf16 v[96:111], v[188:191], v[156:159], 4.0
    v_exp_f32 v80, v80
    v_exp_f32 v81, v81
    v_exp_f32 v82, v82
    v_exp_f32 v83, v83
    v_mfma_f32_32x32x16_bf16 v[96:111], v[184:187], v[152:155], v[96:111]
    v_exp_f32 v84, v84
    s_waitcnt vmcnt(4) lgkmcnt(0)
    s_barrier
    v_exp_f32 v85, v85
    s_setprio 3
    v_exp_f32 v86, v86
    v_exp_f32_e64 v87, v87
    v_smfmac_f32_32x32x32_bf16 v[64:79], v[192:195], v[128:135], v2
    v_exp_f32 v88, v88
    v_exp_f32 v89, v89
    ds_read_b128 v[180:183], v3 offset:32768
    v_exp_f32 v90, v90
    v_exp_f32 v91, v91
    v_smfmac_f32_32x32x32_bf16 v[64:79], v[196:199], v[136:143], v2
    v_exp_f32 v92, v92
    v_exp_f32 v93, v93
    v_exp_f32 v94, v94
    v_exp_f32 v95, v95
    v_mfma_f32_32x32x16_bf16 v[112:127], v[188:191], v[164:167], 4.0
    v_exp_f32 v96, v96
    v_exp_f32 v97, v97
    ds_read_b96 v[176:178], v4 offset:32768
    ds_read_b64_tr_b16 v[192:193], v5 offset:32768
    v_exp_f32 v98, v98
    v_exp_f32 v99, v99
    v_mfma_f32_32x32x16_bf16 v[112:127], v[184:187], v[160:163], v[112:127]
    v_exp_f32 v100, v100
    v_exp_f32 v101, v101
    v_exp_f32 v102, v102
    v_exp_f32 v103, v103
    v_smfmac_f32_32x32x32_bf16 v[16:31], v[200:203], v[80:87], v2
    v_exp_f32 v104, v104
    v_exp_f32 v105, v105
    v_exp_f32 v106, v106
    v_exp_f32 v107, v107
    ds_read_b64_tr_b16 v[194:195], v6 offset:32768
    ds_read_b64_tr_b16 v[196:197], v5 offset:33792
    ds_read_b64_tr_b16 v[198:199], v6 offset:33792
    v_smfmac_f32_32x32x32_bf16 v[16:31], v[204:207], v[88:95], v2
    v_exp_f32 v108, v108
    v_exp_f32 v109, v109
    v_exp_f32 v110, v110
    v_exp_f32 v111, v111
    v_mfma_f32_32x32x16_bf16 v[128:143], v[188:191], v[172:175], 4.0
    v_exp_f32 v112, v112
    v_exp_f32 v113, v113
    v_exp_f32 v114, v114
    v_exp_f32 v115, v115
    v_mfma_f32_32x32x16_bf16 v[128:143], v[184:187], v[168:171], v[128:143]
    v_exp_f32 v116, v116
    v_exp_f32 v117, v117
    v_exp_f32 v118, v118
    v_exp_f32 v119, v119
    v_smfmac_f32_32x32x32_bf16 v[32:47], v[200:203], v[96:103], v2
    v_exp_f32 v120, v120
    v_exp_f32 v121, v121
    v_exp_f32 v122, v122
    v_exp_f32 v123, v123
    v_smfmac_f32_32x32x32_bf16 v[32:47], v[204:207], v[104:111], v2
    v_exp_f32 v124, v124
    v_exp_f32 v125, v125
    v_exp_f32 v126, v126
    v_exp_f32_e64 v127, v127
    s_waitcnt lgkmcnt(0)
    v_mfma_f32_32x32x16_bf16 v[80:95], v[180:183], v[148:151], 4.0
    v_exp_f32 v128, v128
    v_exp_f32 v129, v129
    v_exp_f32 v130, v130
    v_exp_f32 v131, v131
    v_mfma_f32_32x32x16_bf16 v[80:95], v[176:179], v[144:147], v[80:95]
    v_exp_f32 v132, v132
    v_exp_f32 v133, v133
    v_exp_f32 v134, v134
    v_exp_f32 v135, v135
    v_smfmac_f32_32x32x32_bf16 v[48:63], v[200:203], v[112:119], v2
    v_exp_f32 v136, v136
    v_exp_f32 v137, v137
    v_exp_f32 v138, v138
    v_exp_f32 v139, v139
    v_smfmac_f32_32x32x32_bf16 v[48:63], v[204:207], v[120:127], v2
    v_exp_f32 v140, v140
    v_exp_f32 v141, v141
    v_exp_f32 v142, v142
    v_exp_f32 v143, v143
    v_mfma_f32_32x32x16_bf16 v[96:111], v[180:183], v[156:159], 4.0
    v_exp_f32 v80, v80
    v_exp_f32 v81, v81
    v_exp_f32 v82, v82
    v_exp_f32 v83, v83
    v_mfma_f32_32x32x16_bf16 v[96:111], v[176:179], v[152:155], v[96:111]
    v_exp_f32 v84, v84
    ds_read_b96 v[184:186], v4 offset:34816
    v_exp_f32 v85, v85
    ds_read_b128 v[188:191], v3 offset:34816
    v_exp_f32 v86, v86
    v_exp_f32 v87, v87
    v_smfmac_f32_32x32x32_bf16 v[64:79], v[200:203], v[128:135], v2
    v_exp_f32 v88, v88
    v_exp_f32 v89, v89
    v_exp_f32 v90, v90
    v_exp_f32 v91, v91
    v_smfmac_f32_32x32x32_bf16 v[64:79], v[204:207], v[136:143], v2
    v_exp_f32 v92, v92
    v_exp_f32 v93, v93
    v_exp_f32 v94, v94
    v_exp_f32_e64 v95, v95
    s_setprio 2
    v_mfma_f32_32x32x16_bf16 v[112:127], v[180:183], v[164:167], 4.0
    v_exp_f32 v96, v96
    v_exp_f32 v97, v97
    ds_read_b64_tr_b16 v[200:201], v5 offset:34816
    ds_read_b64_tr_b16 v[202:203], v6 offset:34816
    v_exp_f32 v98, v98
    v_exp_f32 v99, v99
    v_mfma_f32_32x32x16_bf16 v[112:127], v[176:179], v[160:163], v[112:127]
    v_exp_f32 v100, v100
    v_exp_f32 v101, v101
    v_exp_f32 v102, v102
    v_exp_f32 v103, v103
    v_smfmac_f32_32x32x32_bf16 v[16:31], v[192:195], v[80:87], v2
    v_exp_f32 v104, v104
    v_exp_f32 v105, v105
    ds_read_b64_tr_b16 v[204:205], v5 offset:35840
    ds_read_b64_tr_b16 v[206:207], v6 offset:35840
    v_exp_f32 v106, v106
    v_exp_f32 v107, v107
    v_smfmac_f32_32x32x32_bf16 v[16:31], v[196:199], v[88:95], v2
    v_exp_f32 v108, v108
    v_exp_f32 v109, v109
    v_exp_f32 v110, v110
    v_exp_f32_e64 v111, v111
    s_waitcnt lgkmcnt(2)
    v_mfma_f32_32x32x16_bf16 v[128:143], v[188:191], v[148:151], 4.0
    v_exp_f32 v112, v112
    v_exp_f32 v113, v113
    v_exp_f32 v114, v114
    v_exp_f32 v115, v115
    v_mfma_f32_32x32x16_bf16 v[128:143], v[184:187], v[144:147], v[128:143]
    v_exp_f32 v116, v116
    v_exp_f32 v117, v117
    s_setprio 1
    v_exp_f32 v118, v118
    v_exp_f32_e64 v119, v119
    v_smfmac_f32_32x32x32_bf16 v[32:47], v[192:195], v[96:103], v2
    v_exp_f32 v120, v120
    v_exp_f32 v121, v121
    v_exp_f32 v122, v122
    v_exp_f32 v123, v123
    v_smfmac_f32_32x32x32_bf16 v[32:47], v[196:199], v[104:111], v2
    v_exp_f32 v124, v124
    v_exp_f32 v125, v125
    v_exp_f32 v126, v126
    v_exp_f32 v127, v127
    v_mfma_f32_32x32x16_bf16 v[80:95], v[188:191], v[156:159], 4.0
    v_exp_f32 v128, v128
    v_exp_f32 v129, v129
    v_exp_f32 v130, v130
    v_exp_f32 v131, v131
    v_mfma_f32_32x32x16_bf16 v[80:95], v[184:187], v[152:155], v[80:95]
    v_exp_f32 v132, v132
    s_setprio 0
    v_exp_f32 v133, v133
    v_exp_f32 v134, v134
    v_exp_f32_e64 v135, v135
    v_smfmac_f32_32x32x32_bf16 v[48:63], v[192:195], v[112:119], v2
    v_exp_f32 v136, v136
    v_exp_f32 v137, v137
    v_exp_f32 v138, v138
    s_waitcnt vmcnt(0) lgkmcnt(0)
    s_barrier
    v_exp_f32 v139, v139
    v_smfmac_f32_32x32x32_bf16 v[48:63], v[196:199], v[120:127], v2
    v_exp_f32 v140, v140
    s_setprio 3
    v_exp_f32 v141, v141
    ds_read_b96 v[232:234], v4 offset:0
    ds_read_b128 v[236:239], v3 offset:0
    v_exp_f32 v142, v142
    v_exp_f32_e64 v143, v143
    v_mfma_f32_32x32x16_bf16 v[96:111], v[188:191], v[164:167], 4.0
    v_exp_f32 v80, v80
    v_exp_f32 v81, v81
    v_exp_f32 v82, v82
    v_exp_f32 v83, v83
    v_mfma_f32_32x32x16_bf16 v[96:111], v[184:187], v[160:163], v[96:111]
    v_exp_f32 v84, v84
    v_exp_f32 v85, v85
    v_exp_f32 v86, v86
    v_exp_f32 v87, v87
    v_smfmac_f32_32x32x32_bf16 v[16:31], v[200:203], v[128:135], v2
    v_exp_f32 v88, v88
    v_exp_f32 v89, v89
    ds_read_b96 v[216:218], v4 offset:2048
    ds_read_b128 v[220:223], v3 offset:2048
    v_exp_f32 v90, v90
    v_exp_f32 v91, v91
    v_smfmac_f32_32x32x32_bf16 v[16:31], v[204:207], v[136:143], v2
    v_exp_f32 v92, v92
    v_exp_f32 v93, v93
    v_exp_f32 v94, v94
    v_exp_f32_e64 v95, v95
    s_waitcnt lgkmcnt(2)
    v_mfma_f32_32x32x16_bf16 v[112:127], v[236:239], v[148:151], 4.0
    v_exp_f32 v96, v96
    v_exp_f32 v97, v97
    ds_read_b64_tr_b16 v[242:243], v6 offset:0
    ds_read_b64_tr_b16 v[224:225], v5 offset:2048
    ds_read_b64_tr_b16 v[226:227], v6 offset:2048
    v_exp_f32 v98, v98
    v_exp_f32 v99, v99
    v_mfma_f32_32x32x16_bf16 v[112:127], v[232:235], v[144:147], v[112:127]
    v_exp_f32 v100, v100
    v_exp_f32 v101, v101
    ds_read_b64_tr_b16 v[240:241], v5 offset:0
    v_exp_f32 v102, v102
    v_exp_f32 v103, v103
    v_smfmac_f32_32x32x32_bf16 v[32:47], v[200:203], v[80:87], v2
    v_exp_f32 v104, v104
    v_exp_f32 v105, v105
    v_exp_f32 v106, v106
    v_exp_f32 v107, v107
    v_smfmac_f32_32x32x32_bf16 v[32:47], v[204:207], v[88:95], v2
    v_exp_f32 v108, v108
    v_exp_f32 v109, v109
    ds_read_b64_tr_b16 v[244:245], v5 offset:1024
    ds_read_b64_tr_b16 v[246:247], v6 offset:1024
    v_exp_f32 v110, v110
    v_exp_f32_e64 v111, v111
    s_waitcnt lgkmcnt(2)
    v_mfma_f32_32x32x16_bf16 v[128:143], v[220:223], v[148:151], 4.0
    v_exp_f32 v112, v112
    v_exp_f32 v113, v113
    v_exp_f32 v114, v114
    v_exp_f32 v115, v115
    v_mfma_f32_32x32x16_bf16 v[128:143], v[216:219], v[144:147], v[128:143]
    v_exp_f32 v116, v116
    v_exp_f32 v117, v117
    v_exp_f32 v118, v118
    v_exp_f32 v119, v119
    v_smfmac_f32_32x32x32_bf16 v[48:63], v[200:203], v[96:103], v2
    v_exp_f32 v120, v120
    v_exp_f32 v121, v121
    v_exp_f32 v122, v122
    v_exp_f32 v123, v123
    v_smfmac_f32_32x32x32_bf16 v[48:63], v[204:207], v[104:111], v2
    v_exp_f32 v124, v124
    v_exp_f32 v125, v125
    ds_read_b64_tr_b16 v[228:229], v5 offset:3072
    v_exp_f32 v126, v126
    v_exp_f32 v127, v127
    v_mfma_f32_32x32x16_bf16 v[80:95], v[236:239], v[156:159], 4.0
    v_exp_f32 v128, v128
    v_exp_f32 v129, v129
    ds_read_b64_tr_b16 v[230:231], v6 offset:3072
    v_exp_f32 v130, v130
    v_exp_f32 v131, v131
    v_mfma_f32_32x32x16_bf16 v[80:95], v[232:235], v[152:155], v[80:95]
    v_exp_f32 v132, v132
    v_exp_f32 v133, v133
    v_exp_f32 v134, v134
    v_exp_f32 v135, v135
    v_smfmac_f32_32x32x32_bf16 v[16:31], v[240:243], v[112:119], v2
    v_exp_f32 v136, v136
    v_exp_f32 v137, v137
    v_exp_f32 v138, v138
    v_exp_f32_e64 v139, v139
    s_waitcnt lgkmcnt(0)
    v_smfmac_f32_32x32x32_bf16 v[16:31], v[244:247], v[120:127], v2
    v_exp_f32 v140, v140
    v_exp_f32 v141, v141
    v_exp_f32 v142, v142
    v_exp_f32 v143, v143
    v_mfma_f32_32x32x16_bf16 v[96:111], v[220:223], v[156:159], 4.0
    v_exp_f32 v80, v80
    v_exp_f32 v81, v81
    v_exp_f32 v82, v82
    v_exp_f32 v83, v83
    v_mfma_f32_32x32x16_bf16 v[96:111], v[216:219], v[152:155], v[96:111]
    v_exp_f32 v84, v84
    v_exp_f32 v85, v85
    v_exp_f32 v86, v86
    v_exp_f32 v87, v87
    v_smfmac_f32_32x32x32_bf16 v[16:31], v[224:227], v[128:135], v2
    v_exp_f32 v88, v88
    v_exp_f32 v89, v89
    v_exp_f32 v90, v90
    v_exp_f32 v91, v91
    v_smfmac_f32_32x32x32_bf16 v[16:31], v[228:231], v[136:143], v2
    v_exp_f32 v92, v92
    v_exp_f32 v93, v93
    v_exp_f32 v94, v94
    s_setprio 2
    v_exp_f32_e64 v95, v95
    v_mfma_f32_32x32x16_bf16 v[112:127], v[236:239], v[164:167], 4.0
    v_exp_f32 v96, v96
    v_exp_f32 v97, v97
    v_exp_f32 v98, v98
    v_exp_f32 v99, v99
    v_mfma_f32_32x32x16_bf16 v[112:127], v[232:235], v[160:163], v[112:127]
    v_exp_f32 v100, v100
    v_exp_f32 v101, v101
    v_exp_f32 v102, v102
    v_exp_f32 v103, v103
    v_smfmac_f32_32x32x32_bf16 v[32:47], v[240:243], v[80:87], v2
    v_exp_f32 v104, v104
    v_exp_f32 v105, v105
    ds_write_b128 v208, v[16:19] offset:0
    v_exp_f32 v106, v106
    v_exp_f32 v107, v107
    v_smfmac_f32_32x32x32_bf16 v[32:47], v[244:247], v[88:95], v2
    v_exp_f32 v108, v108
    v_exp_f32 v109, v109
    v_exp_f32 v110, v110
    ds_write_b128 v208, v[20:23] offset:1024
    v_exp_f32 v111, v111
    v_mfma_f32_32x32x16_bf16 v[128:143], v[220:223], v[164:167], 4.0
    v_exp_f32 v112, v112
    v_exp_f32 v113, v113
    v_exp_f32 v114, v114
    v_exp_f32 v115, v115
    v_mfma_f32_32x32x16_bf16 v[128:143], v[216:219], v[160:163], v[128:143]
    v_exp_f32 v116, v116
    v_exp_f32 v117, v117
    v_exp_f32 v118, v118
    ds_write_b128 v208, v[24:27] offset:2048
    v_exp_f32 v119, v119
    v_smfmac_f32_32x32x32_bf16 v[32:47], v[224:227], v[96:103], v2
    v_exp_f32 v120, v120
    v_exp_f32 v121, v121
    ds_write_b128 v208, v[28:31] offset:3072
    v_exp_f32 v122, v122
    v_exp_f32 v123, v123
    v_smfmac_f32_32x32x32_bf16 v[32:47], v[228:231], v[104:111], v2
    v_exp_f32 v124, v124
    v_exp_f32 v125, v125
    v_exp_f32 v126, v126
    v_exp_f32 v127, v127
    v_mfma_f32_32x32x16_bf16 v[80:95], v[180:183], v[172:175], 4.0
    v_exp_f32 v128, v128
    v_exp_f32 v129, v129
    v_exp_f32 v130, v130
    v_exp_f32 v131, v131
    v_mfma_f32_32x32x16_bf16 v[80:95], v[176:179], v[168:171], v[80:95]
    v_exp_f32 v132, v132
    v_exp_f32 v133, v133
    ds_write_b128 v209, v[32:35] offset:32768
    ds_write_b128 v209, v[40:43] offset:34816
    v_exp_f32 v134, v134
    v_exp_f32 v135, v135
    v_smfmac_f32_32x32x32_bf16 v[48:63], v[240:243], v[112:119], v2
    v_exp_f32 v136, v136
    v_exp_f32 v137, v137
    v_exp_f32 v138, v138
    v_exp_f32 v139, v139
    v_smfmac_f32_32x32x32_bf16 v[48:63], v[244:247], v[120:127], v2
    v_exp_f32 v140, v140
    v_exp_f32 v141, v141
    ds_write_b128 v209, v[36:39] offset:33792
    v_exp_f32 v142, v142
    v_exp_f32 v143, v143
    v_mfma_f32_32x32x16_bf16 v[96:111], v[188:191], v[172:175], 4.0
    v_exp_f32 v80, v80
    v_exp_f32 v81, v81
    v_exp_f32 v82, v82
    v_exp_f32 v83, v83
    v_mfma_f32_32x32x16_bf16 v[96:111], v[184:187], v[168:171], v[96:111]
    v_exp_f32 v84, v84
    v_exp_f32 v85, v85
    v_exp_f32 v86, v86
    v_exp_f32 v87, v87
    v_smfmac_f32_32x32x32_bf16 v[48:63], v[224:227], v[128:135], v2
    v_exp_f32 v88, v88
    s_setprio 1
    v_exp_f32 v89, v89
    v_exp_f32 v90, v90
    v_exp_f32_e64 v91, v91
    v_smfmac_f32_32x32x32_bf16 v[48:63], v[228:231], v[136:143], v2
    v_exp_f32 v92, v92
    v_exp_f32 v93, v93
    ds_write_b128 v209, v[44:47] offset:35840
    v_exp_f32 v94, v94
    v_exp_f32 v95, v95
    v_mfma_f32_32x32x16_bf16 v[112:127], v[236:239], v[172:175], 4.0
    v_exp_f32 v96, v96
    v_exp_f32 v97, v97
    v_exp_f32 v98, v98
    v_exp_f32 v99, v99
    v_mfma_f32_32x32x16_bf16 v[112:127], v[232:235], v[168:171], v[112:127]
    v_exp_f32 v100, v100
    v_exp_f32 v101, v101
    v_exp_f32 v102, v102
    v_exp_f32 v103, v103
    ds_write_b128 v211, v[48:51] offset:0
    v_smfmac_f32_32x32x32_bf16 v[64:79], v[192:195], v[80:87], v2
    v_exp_f32 v104, v104
    v_exp_f32 v105, v105
    v_exp_f32 v106, v106
    ds_write_b128 v211, v[52:55] offset:1024
    v_exp_f32 v107, v107
    ds_write_b128 v211, v[56:59] offset:2048
    v_smfmac_f32_32x32x32_bf16 v[64:79], v[196:199], v[88:95], v2
    v_exp_f32 v108, v108
    s_setprio 0
    v_exp_f32 v109, v109
    ds_write_b128 v211, v[60:63] offset:3072
    v_exp_f32 v110, v110
    v_exp_f32_e64 v111, v111
    v_mfma_f32_32x32x16_bf16 v[128:143], v[220:223], v[172:175], 4.0
    v_exp_f32 v112, v112
    v_exp_f32 v113, v113
    v_exp_f32 v114, v114
    v_exp_f32 v115, v115
    v_mfma_f32_32x32x16_bf16 v[128:143], v[216:219], v[168:171], v[128:143]
    v_exp_f32 v116, v116
    v_exp_f32 v117, v117
    v_exp_f32 v118, v118
    v_exp_f32 v119, v119
    v_smfmac_f32_32x32x32_bf16 v[64:79], v[200:203], v[96:103], v2
    v_exp_f32 v120, v120
    v_exp_f32 v121, v121
    s_setprio 1
    v_exp_f32 v122, v122
    v_exp_f32_e64 v123, v123
    v_smfmac_f32_32x32x32_bf16 v[64:79], v[204:207], v[104:111], v2
    v_exp_f32 v124, v124
    s_waitcnt lgkmcnt(0)
    s_barrier
    v_exp_f32 v125, v125
    v_exp_f32 v126, v126
    v_exp_f32 v127, v127
    v_exp_f32 v128, v128
    ds_read_b128 v[28:31], v14 offset:3072
    ds_read_b128 v[44:47], v14 offset:35840
    ds_read_b128 v[60:63], v15 offset:3072
    v_exp_f32 v129, v129
    v_smfmac_f32_32x32x32_bf16 v[64:79], v[240:243], v[112:119], v2
    v_exp_f32 v130, v130
    v_exp_f32 v131, v131
    ds_read_b128 v[16:19], v14 offset:0
    ds_read_b128 v[32:35], v14 offset:32768
    ds_read_b128 v[48:51], v15 offset:0
    v_smfmac_f32_32x32x32_bf16 v[64:79], v[244:247], v[120:127], v2
    v_exp_f32 v132, v132
    v_exp_f32 v133, v133
    v_exp_f32 v134, v134
    ds_read_b128 v[20:23], v14 offset:1024
    ds_read_b128 v[36:39], v14 offset:33792
    ds_read_b128 v[52:55], v15 offset:1024
    v_exp_f32 v135, v135
    v_exp_f32 v136, v136
    s_setprio 0
    v_smfmac_f32_32x32x32_bf16 v[64:79], v[224:227], v[128:135], v2
    v_exp_f32 v137, v137
    v_exp_f32 v138, v138
    ds_read_b128 v[24:27], v14 offset:2048
    ds_read_b128 v[40:43], v14 offset:34816
    ds_read_b128 v[56:59], v15 offset:2048
    v_exp_f32 v139, v139
    v_exp_f32 v140, v140
    v_exp_f32 v141, v141
    v_exp_f32 v142, v142
    v_exp_f32 v143, v143
    s_waitcnt lgkmcnt(3)
    v_pk_add_f32 v[28:29], v[28:29], v[44:45]
    v_pk_add_f32 v[30:31], v[30:31], v[46:47]
    v_smfmac_f32_32x32x32_bf16 v[64:79], v[228:231], v[136:143], v2
    v_pk_add_f32 v[16:17], v[16:17], v[32:33]
    v_pk_add_f32 v[18:19], v[18:19], v[34:35]
    v_pk_add_f32 v[28:29], v[28:29], v[60:61]
    v_pk_add_f32 v[30:31], v[30:31], v[62:63]
    v_pk_add_f32 v[20:21], v[20:21], v[36:37]
    v_pk_add_f32 v[22:23], v[22:23], v[38:39]
    v_pk_add_f32 v[16:17], v[16:17], v[48:49]
    v_pk_add_f32 v[18:19], v[18:19], v[50:51]
    s_waitcnt lgkmcnt(0)
    v_pk_add_f32 v[24:25], v[24:25], v[40:41]
    v_pk_add_f32 v[26:27], v[26:27], v[42:43]
    v_pk_add_f32 v[20:21], v[20:21], v[52:53]
    v_pk_add_f32 v[22:23], v[22:23], v[54:55]
    v_pk_add_f32 v[24:25], v[24:25], v[56:57]
    v_pk_add_f32 v[26:27], v[26:27], v[58:59]
    v_pk_add_f32 v[76:77], v[76:77], v[28:29]
    v_pk_add_f32 v[78:79], v[78:79], v[30:31]
    v_mov_b32 v11, v76
    v_mov_b32 v10, v76
    v_subrev_u32 v12, s39, v76
    v_cmp_lt_u32 vcc, s40, v12
    v_permlane32_swap_b32 v11, v10
    v_pk_add_f32 v[64:65], v[64:65], v[16:17]
    v_pk_add_f32 v[66:67], v[66:67], v[18:19]
    v_rcp_f32 v10, v10
    v_pk_add_f32 v[68:69], v[68:69], v[20:21]
    v_pk_add_f32 v[70:71], v[70:71], v[22:23]
    v_pk_add_f32 v[72:73], v[72:73], v[24:25]
    v_pk_add_f32 v[74:75], v[74:75], v[26:27]
    s_mov_b32 s32, vcc_hi
L_norm:
    v_pk_mul_f32 v[76:77], v[76:77], v[10:11] op_sel_hi:[1,0]
    v_pk_mul_f32 v[78:79], v[78:79], v[10:11] op_sel_hi:[1,0]
    v_cvt_pk_bf16_f32 v102, v76, v77
    v_cvt_pk_bf16_f32 v103, v78, v79
    ds_write_b64 v214, v[102:103] offset:24
    v_pk_mul_f32 v[64:65], v[64:65], v[10:11] op_sel_hi:[1,0]
    v_pk_mul_f32 v[66:67], v[66:67], v[10:11] op_sel_hi:[1,0]
    v_cvt_pk_bf16_f32 v96, v64, v65
    v_cvt_pk_bf16_f32 v97, v66, v67
    ds_write_b64 v214, v[96:97] offset:0
    v_pk_mul_f32 v[68:69], v[68:69], v[10:11] op_sel_hi:[1,0]
    v_pk_mul_f32 v[70:71], v[70:71], v[10:11] op_sel_hi:[1,0]
    v_cvt_pk_bf16_f32 v98, v68, v69
    v_cvt_pk_bf16_f32 v99, v70, v71
    ds_write_b64 v214, v[98:99] offset:8
    v_pk_mul_f32 v[72:73], v[72:73], v[10:11] op_sel_hi:[1,0]
    v_pk_mul_f32 v[74:75], v[74:75], v[10:11] op_sel_hi:[1,0]
    v_cvt_pk_bf16_f32 v100, v72, v73
    v_cvt_pk_bf16_f32 v101, v74, v75
    ds_write_b64 v214, v[100:101] offset:16
    ds_read_b128 v[112:115], v14
    ds_read_b128 v[116:119], v14 offset:1024
    v_pk_mul_f32 v[32:33], v[76:77], 0
    v_pk_mul_f32 v[34:35], v[78:79], 0
    v_pk_fma_f32 v[32:33], v[64:65], 0, v[32:33]
    v_pk_fma_f32 v[34:35], v[66:67], 0, v[34:35]
    v_pk_fma_f32 v[32:33], v[68:69], 0, v[32:33]
    v_pk_fma_f32 v[34:35], v[70:71], 0, v[34:35]
    v_pk_fma_f32 v[32:33], v[72:73], 0, v[32:33]
    v_pk_fma_f32 v[34:35], v[74:75], 0, v[34:35]
    v_pk_add_f32 v[32:33], v[32:33], v[34:35]
    v_cmp_u_f32 vcc, v32, v33
    s_nop 0
    s_or_b32 s32, s32, vcc_lo
    s_or_b32 s32, s32, vcc_hi
    s_and_b32 s32, s32, s42
    s_cbranch_scc1 L_slow
    s_waitcnt lgkmcnt(1)
    buffer_store_dwordx4 v[112:115], v8, s[24:27], s36 offen
    s_mov_b32 exec_hi, 0x0000ffff
    s_waitcnt lgkmcnt(0)
    buffer_store_dwordx4 v[116:119], v8, s[24:27], s36 offen offset:1024
L_end:
    s_endpgm
L_slow:
    s_waitcnt lgkmcnt(0)
    s_mov_b32 s42, 0
    v_mov_b32 v112, 0xff800000
    s_mov_b32 s30, s37
L_slow1:
    buffer_load_dwordx3 v[176:178], v0, s[12:15], s30 offen offset:32
    buffer_load_dwordx4 v[180:183], v215, s[12:15], s30 offen offset:0
    s_waitcnt vmcnt(0)
    v_mfma_f32_32x32x16_bf16 v[80:95], v[176:179], v[168:171], 0
    v_mfma_f32_32x32x16_bf16 v[80:95], v[180:183], v[172:175], v[80:95]
    s_add_u32 s30, s30, 1792
    s_cmp_lt_u32 s30, s38
    s_nop 11
    v_max3_f32 v112, v112, v80, v81
    v_max3_f32 v112, v112, v82, v83
    v_max3_f32 v112, v112, v84, v85
    v_max3_f32 v112, v112, v86, v87
    v_max3_f32 v112, v112, v88, v89
    v_max3_f32 v112, v112, v90, v91
    v_max3_f32 v112, v112, v92, v93
    v_max3_f32 v112, v112, v94, v95
    s_cbranch_scc1 L_slow1
    v_mov_b32 v113, v112
    s_nop 1
    v_permlane32_swap_b32 v112, v113
    s_nop 1
    v_max_f32 v112, v112, v113
    v_sub_f32 v112, 0, v112
    v_mov_b32 v113, v112
    v_mov_b32 v114, v112
    v_mov_b32 v115, v112
    v_mov_b32 v116, v112
    v_mov_b32 v117, v112
    v_mov_b32 v118, v112
    v_mov_b32 v119, v112
    v_mov_b32 v120, v112
    v_mov_b32 v121, v112
    v_mov_b32 v122, v112
    v_mov_b32 v123, v112
    v_mov_b32 v124, v112
    v_mov_b32 v125, v112
    v_mov_b32 v126, v112
    v_mov_b32 v127, v112
    v_mov_b32 v64, 0
    v_mov_b32 v65, 0
    v_mov_b32 v66, 0
    v_mov_b32 v67, 0
    v_mov_b32 v68, 0
    v_mov_b32 v69, 0
    v_mov_b32 v70, 0
    v_mov_b32 v71, 0
    v_mov_b32 v72, 0
    v_mov_b32 v73, 0
    v_mov_b32 v74, 0
    v_mov_b32 v75, 0
    v_mov_b32 v76, 0
    v_mov_b32 v77, 0
    v_mov_b32 v78, 0
    v_mov_b32 v79, 0
    s_lshl_b32 s32, s28, 11
    s_lshl_b32 s33, s29, 12
    s_sub_u32 s33, s32, s33
    v_add_u32 v5, s33, v5
    v_add_u32 v6, s33, v6
    s_add_u32 s32, s32, 49152
    s_mov_b32 s30, s37
L_slow2:
    buffer_load_dwordx3 v[176:178], v0, s[12:15], s30 offen offset:32
    buffer_load_dwordx4 v[180:183], v215, s[12:15], s30 offen offset:0
    s_mov_b32 m0, s32
    s_mov_b32 exec_hi, 0x00ffffff
    buffer_load_dwordx4 v8, s[16:19], s30 offen lds
    s_add_u32 m0, s32, 128
    s_nop 0
    buffer_load_dwordx4 v8, s[16:19], s30 offen offset:896 lds
    s_mov_b32 exec_hi, -1
    s_waitcnt vmcnt(0)
    ds_read_b64_tr_b16 v[192:193], v5 offset:0
    ds_read_b64_tr_b16 v[194:195], v6 offset:0
    ds_read_b64_tr_b16 v[196:197], v5 offset:1024
    ds_read_b64_tr_b16 v[198:199], v6 offset:1024
    v_mfma_f32_32x32x16_bf16 v[80:95], v[176:179], v[168:171], v[112:127]
    v_mfma_f32_32x32x16_bf16 v[80:95], v[180:183], v[172:175], v[80:95]
    s_add_u32 s30, s30, 1792
    s_cmp_lt_u32 s30, s38
    s_nop 11
    v_exp_f32 v80, v80
    v_exp_f32 v81, v81
    v_exp_f32 v82, v82
    v_exp_f32 v83, v83
    v_exp_f32 v84, v84
    v_exp_f32 v85, v85
    v_exp_f32 v86, v86
    v_exp_f32 v87, v87
    v_exp_f32 v88, v88
    v_exp_f32 v89, v89
    v_exp_f32 v90, v90
    v_exp_f32 v91, v91
    v_exp_f32 v92, v92
    v_exp_f32 v93, v93
    v_exp_f32 v94, v94
    v_exp_f32_e64 v95, v95
    s_waitcnt lgkmcnt(0)
    s_nop 1
    v_smfmac_f32_32x32x32_bf16 v[64:79], v[192:195], v[80:87], v2
    v_smfmac_f32_32x32x32_bf16 v[64:79], v[196:199], v[88:95], v2
    s_cbranch_scc1 L_slow2
    s_nop 15
    v_mov_b32 v11, v76
    v_mov_b32 v10, v76
    s_nop 1
    v_permlane32_swap_b32 v11, v10
    s_nop 1
    v_rcp_f32 v10, v10
    s_nop 0
    s_branch L_norm
.section .rodata,"a"
.p2align 6
.amdhsa_kernel standalone__fused_io_aware_attn__prompt_kernel
  .amdhsa_next_free_vgpr 248
  .amdhsa_next_free_sgpr 48
  .amdhsa_accum_offset 248
  .amdhsa_group_segment_fixed_size 0
  .amdhsa_kernarg_size 48
  .amdhsa_user_sgpr_count 2
  .amdhsa_user_sgpr_kernarg_segment_ptr 1
  .amdhsa_system_sgpr_workgroup_id_x 1
.end_amdhsa_kernel
```
